```python
import torch

def _softmax(x, axis=-1):
    return torch.softmax(x, dim=axis)

def _gelu(x):
    return torch.nn.functional.gelu(x, approximate='tanh')

def _silu(x):
    return torch.nn.functional.silu(x)

def _sigmoid(x):
    return torch.sigmoid(x)

def _layernorm(x, axis=-1, eps=1e-05):
    m = x.mean(dim=axis, keepdim=True)
    v = x.var(dim=axis, keepdim=True, unbiased=False)
    return (x - m) / torch.sqrt(v + eps)

def _scatter_add(tgt, idx, src, axis=0):
    return tgt.clone().index_add_(axis, idx, src)

def _segment_sum(src, seg, n):
    out = torch.zeros((n,) + src.shape[1:], dtype=src.dtype)
    return out.index_add_(0, seg, src)

def _pad(x, pw):
    flat = tuple((v for pair in reversed(pw) for v in pair))
    return torch.nn.functional.pad(x, flat)
kernel_name = 'standalone__video_timesformer__vision'

def setup_inputs():

    _w = lambda a: (lambda t: t.to(torch.bfloat16) if t.is_floating_point() else t)(torch.as_tensor(a))
    T = 8
    p = 16
    HW = 256 // p * p
    N = (HW // p) ** 2
    C = 384
    return {'x': _w((lambda *s: torch.randn(*s, dtype=torch.bfloat16) * 0.05)(1, T, N, C)), 'wqkv_t': _w((lambda *s: torch.randn(*s, dtype=torch.bfloat16) * 0.05)(C, 3 * C)), 'wo_t': _w((lambda *s: torch.randn(*s, dtype=torch.bfloat16) * 0.05)(C, C)), 'wqkv_s': _w((lambda *s: torch.randn(*s, dtype=torch.bfloat16) * 0.05)(C, 3 * C)), 'wo_s': _w((lambda *s: torch.randn(*s, dtype=torch.bfloat16) * 0.05)(C, C))}

def reference(x, wqkv_t, wo_t, wqkv_s, wo_s):
    B, T, N, C = x.shape
    scale = C ** (-0.5)
    xt = (lambda x, *d: x.permute(*d))(x, 0, 2, 1, 3).reshape(B * N, T, C)
    h = _layernorm(xt, axis=-1)
    qkv = h @ wqkv_t
    q, k, v = (qkv[..., :C].clone(), qkv[..., C:2 * C].clone(), qkv[..., 2 * C:].clone())
    a = _softmax(torch.einsum('btc,bsc->bts', q, k) * scale, axis=-1)
    xt = xt + torch.einsum('bts,bsc->btc', a, v) @ wo_t
    x1 = (lambda x, *d: x.permute(*d))(xt.reshape(B, N, T, C), 0, 2, 1, 3)
    xs = x1.reshape(B * T, N, C)
    h = _layernorm(xs, axis=-1)
    qkv = h @ wqkv_s
    q, k, v = (qkv[..., :C].clone(), qkv[..., C:2 * C].clone(), qkv[..., 2 * C:].clone())
    a = _softmax(torch.einsum('bnc,bmc->bnm', q, k) * scale, axis=-1)
    xs = xs + torch.einsum('bnm,bmc->bnc', a, v) @ wo_s
    return xs.reshape(B, T, N, C)
```

```asm
; @launch grid=(256,1,1) block=(512,1,1) lds=151552
.amdgcn_target "amdgcn-amd-amdhsa--gfx950"
.text
.globl standalone__video_timesformer__vision_kernel
.p2align 8
.type standalone__video_timesformer__vision_kernel,@function
standalone__video_timesformer__vision_kernel:
  s_cmp_ge_u32 s2, 256
  s_cbranch_scc1 K_end
  s_load_dwordx4 s[20:23], s[0:1], 0
  s_load_dwordx4 s[28:31], s[0:1], 16
  s_load_dwordx4 s[36:39], s[0:1], 32
  s_load_dwordx2 s[32:33], s[0:1], 56
  v_and_b32 v1, 63, v0
  v_lshrrev_b32 v2, 6, v0
  s_and_b32 s40, s2, 7
  v_readfirstlane_b32 s41, v2
  s_lshr_b32 s42, s2, 3
  s_lshr_b32 s43, s41, 2
  s_and_b32 s41, s41, 3
  v_lshrrev_b32 v2, 3, v1
  v_and_b32 v3, 7, v1
  v_lshlrev_b32 v10, 4, v1
  s_cmp_lt_u32 s42, 8
  s_cbranch_scc1 K_pre
A_main:
  s_sub_u32 s51, s42, 8
  s_mul_i32 s34, s51, 43
  s_lshr_b32 s34, s34, 8
  s_mul_i32 s35, s34, 6
  s_sub_u32 s51, s51, s35
  s_lshl_b32 s50, s40, 2
  s_add_u32 s50, s50, s34
  s_lshl_b32 s55, s41, 11
  s_mul_i32 s3, s40, 3
  s_lshr_b32 s3, s3, 2
  s_add_u32 s3, s3, s51
  s_cmp_ge_u32 s3, 6
  s_cselect_b32 s34, 6, 0
  s_sub_u32 s3, s3, s34
  s_cmp_eq_u32 s43, 0
  s_cbranch_scc1 A_c
  s_mov_b32 s35, 196608
  v_mul_lo_u32 v36, v2, s35
  v_lshrrev_b32 v4, 1, v2
  v_xor_b32 v4, v4, v3
  v_lshl_add_u32 v36, v4, 4, v36
  v_xor_b32 v37, 64, v36
  v_add_u32 v37, 768, v37
  s_lshl_b32 s34, s50, 3
  s_lshl_b32 s35, s41, 1
  s_add_u32 s34, s34, s35
  s_mul_i32 s54, s34, 768
  v_lshlrev_b32 v4, 1, v2
  v_and_b32 v4, 4, v4
  v_xor_b32 v4, v4, v3
  v_mul_u32_u24 v32, 2304, v2
  v_lshl_add_u32 v32, v4, 4, v32
  s_mul_i32 s68, s41, 36864
  s_lshl_b32 s34, s51, 7
  s_add_u32 s68, s68, s34
  v_add_u32 v33, 18432, v32
  v_add_u32 v34, 768, v32
  v_add_u32 v35, 19200, v32
  s_lshl_b32 s34, s3, 7
  s_add_u32 s62, s34, s54
  s_mul_i32 s34, s3, 147456
  s_add_u32 s56, s34, s68
  s_mov_b32 s6, 1572864
  s_mov_b32 s7, 0x20000
  s_mov_b32 s10, 884736
  s_mov_b32 s11, 0x20000
  s_waitcnt lgkmcnt(0)
  s_mov_b32 s4, s20
  s_mov_b32 s5, s21
  s_mov_b32 s8, s22
  s_mov_b32 s9, s23
  s_add_u32 m0, s55, 0
  s_nop 0
  buffer_load_dwordx4 v36, s[4:7], s62 offen lds
  s_add_u32 m0, s55, 1024
  s_nop 0
  buffer_load_dwordx4 v37, s[4:7], s62 offen lds
  s_add_u32 m0, s55, 49152
  s_nop 0
  buffer_load_dwordx4 v32, s[8:11], s56 offen lds
  s_add_u32 m0, s55, 50176
  s_nop 0
  buffer_load_dwordx4 v33, s[8:11], s56 offen lds
  s_add_u32 m0, s55, 57344
  s_nop 0
  buffer_load_dwordx4 v34, s[8:11], s56 offen lds
  s_add_u32 m0, s55, 58368
  s_nop 0
  buffer_load_dwordx4 v35, s[8:11], s56 offen lds
  s_add_u32 s3, s3, 1
  s_cmp_ge_u32 s3, 6
  s_cselect_b32 s3, 0, s3
  s_lshl_b32 s34, s3, 7
  s_add_u32 s63, s34, s54
  s_mul_i32 s34, s3, 147456
  s_add_u32 s57, s34, s68
  s_add_u32 m0, s55, 8192
  s_nop 0
  buffer_load_dwordx4 v36, s[4:7], s63 offen lds
  s_add_u32 m0, s55, 9216
  s_nop 0
  buffer_load_dwordx4 v37, s[4:7], s63 offen lds
  s_add_u32 m0, s55, 65536
  s_nop 0
  buffer_load_dwordx4 v32, s[8:11], s57 offen lds
  s_add_u32 m0, s55, 66560
  s_nop 0
  buffer_load_dwordx4 v33, s[8:11], s57 offen lds
  s_add_u32 m0, s55, 73728
  s_nop 0
  buffer_load_dwordx4 v34, s[8:11], s57 offen lds
  s_add_u32 m0, s55, 74752
  s_nop 0
  buffer_load_dwordx4 v35, s[8:11], s57 offen lds
  s_add_u32 s3, s3, 1
  s_cmp_ge_u32 s3, 6
  s_cselect_b32 s3, 0, s3
  s_lshl_b32 s34, s3, 7
  s_add_u32 s64, s34, s54
  s_mul_i32 s34, s3, 147456
  s_add_u32 s58, s34, s68
  s_mov_b32 s34, 8077312
  s_load_dword s44, s[32:33], s34
  s_add_u32 s3, s3, 1
  s_cmp_ge_u32 s3, 6
  s_cselect_b32 s3, 0, s3
  s_lshl_b32 s34, s3, 7
  s_add_u32 s65, s34, s54
  s_mul_i32 s34, s3, 147456
  s_add_u32 s59, s34, s68
  s_add_u32 s3, s3, 1
  s_cmp_ge_u32 s3, 6
  s_cselect_b32 s3, 0, s3
  s_lshl_b32 s34, s3, 7
  s_add_u32 s66, s34, s54
  s_mul_i32 s34, s3, 147456
  s_add_u32 s60, s34, s68
  s_add_u32 s3, s3, 1
  s_cmp_ge_u32 s3, 6
  s_cselect_b32 s3, 0, s3
  s_lshl_b32 s34, s3, 7
  s_add_u32 s67, s34, s54
  s_mul_i32 s34, s3, 147456
  s_add_u32 s61, s34, s68
  s_mov_b32 s16, s32
  s_mov_b32 s17, s33
  s_mov_b32 s18, 16777216
  s_mov_b32 s19, 0x20000
  s_mov_b32 s24, s38
  s_mov_b32 s25, s39
  s_mov_b32 s26, 1572864
  s_mov_b32 s27, 0x20000
  s_lshl_b32 s47, s41, 10
  s_getreg_b32 s45, hwreg(HW_REG_XCC_ID)
  s_and_b32 s45, s45, 15
  s_add_u32 s45, s45, 1
  v_mul_u32_u24 v38, 768, v1
  s_lshl_b32 s34, s51, 7
  s_add_u32 s68, s34, 8028160
  s_mul_i32 s69, s51, 53248
  s_add_u32 s69, s69, 0
  s_waitcnt lgkmcnt(0)
  s_mul_i32 s44, s44, 0x9e3779b1
  s_add_u32 s44, s44, 0x7f4a7c15
  s_add_u32 s45, s45, s44
  s_cmp_lg_u32 s42, 8
  s_cbranch_scc1 pg_7
  s_cmp_lg_u32 s41, 0
  s_cbranch_scc1 pg_7
  s_lshl_b32 s34, s40, 7
  s_mov_b32 s35, 8019968
  s_mov_b64 exec, 1
  v_mov_b32 v52, s34
  v_mov_b32 v53, s45
  buffer_store_dword v53, v52, s[16:19], s35 offen
  s_mov_b64 exec, -1
pg_7:
  s_waitcnt vmcnt(6)
  s_barrier
  s_add_u32 m0, s55, 16384
  s_nop 0
  buffer_load_dwordx4 v36, s[4:7], s64 offen lds
  s_add_u32 m0, s55, 17408
  s_nop 0
  buffer_load_dwordx4 v37, s[4:7], s64 offen lds
  s_add_u32 m0, s55, 81920
  s_nop 0
  buffer_load_dwordx4 v32, s[8:11], s58 offen lds
  s_add_u32 m0, s55, 82944
  s_nop 0
  buffer_load_dwordx4 v33, s[8:11], s58 offen lds
  s_add_u32 m0, s55, 90112
  s_nop 0
  buffer_load_dwordx4 v34, s[8:11], s58 offen lds
  s_add_u32 m0, s55, 91136
  s_nop 0
  buffer_load_dwordx4 v35, s[8:11], s58 offen lds
  s_waitcnt vmcnt(6)
  s_barrier
  s_add_u32 m0, s55, 24576
  s_nop 0
  buffer_load_dwordx4 v36, s[4:7], s65 offen lds
  s_add_u32 m0, s55, 25600
  s_nop 0
  buffer_load_dwordx4 v37, s[4:7], s65 offen lds
  s_add_u32 m0, s55, 98304
  s_nop 0
  buffer_load_dwordx4 v32, s[8:11], s59 offen lds
  s_add_u32 m0, s55, 99328
  s_nop 0
  buffer_load_dwordx4 v33, s[8:11], s59 offen lds
  s_add_u32 m0, s55, 106496
  s_nop 0
  buffer_load_dwordx4 v34, s[8:11], s59 offen lds
  s_add_u32 m0, s55, 107520
  s_nop 0
  buffer_load_dwordx4 v35, s[8:11], s59 offen lds
  s_waitcnt vmcnt(6)
  s_barrier
  s_add_u32 m0, s55, 32768
  s_nop 0
  buffer_load_dwordx4 v36, s[4:7], s66 offen lds
  s_add_u32 m0, s55, 33792
  s_nop 0
  buffer_load_dwordx4 v37, s[4:7], s66 offen lds
  s_add_u32 m0, s55, 114688
  s_nop 0
  buffer_load_dwordx4 v32, s[8:11], s60 offen lds
  s_add_u32 m0, s55, 115712
  s_nop 0
  buffer_load_dwordx4 v33, s[8:11], s60 offen lds
  s_add_u32 m0, s55, 122880
  s_nop 0
  buffer_load_dwordx4 v34, s[8:11], s60 offen lds
  s_add_u32 m0, s55, 123904
  s_nop 0
  buffer_load_dwordx4 v35, s[8:11], s60 offen lds
  s_waitcnt vmcnt(6)
  s_barrier
  s_add_u32 m0, s55, 40960
  s_nop 0
  buffer_load_dwordx4 v36, s[4:7], s67 offen lds
  s_add_u32 m0, s55, 41984
  s_nop 0
  buffer_load_dwordx4 v37, s[4:7], s67 offen lds
  s_add_u32 m0, s55, 131072
  s_nop 0
  buffer_load_dwordx4 v32, s[8:11], s61 offen lds
  s_add_u32 m0, s55, 132096
  s_nop 0
  buffer_load_dwordx4 v33, s[8:11], s61 offen lds
  s_add_u32 m0, s55, 139264
  s_nop 0
  buffer_load_dwordx4 v34, s[8:11], s61 offen lds
  s_add_u32 m0, s55, 140288
  s_nop 0
  buffer_load_dwordx4 v35, s[8:11], s61 offen lds
  s_mul_i32 s34, s50, 24576
  s_lshl_b32 s35, s51, 12
  s_add_u32 s34, s34, s35
  s_add_u32 s34, s34, 1572864
  s_add_u32 s34, s34, s47
  buffer_load_dwordx4 v[44:47], v10, s[16:19], s34 offen
  s_lshl_b32 s34, s50, 8
  s_add_u32 s34, s34, 7995392
  v_lshlrev_b32 v48, 2, v1
  buffer_load_dword v49, v48, s[16:19], s34 offen
  s_lshl_b32 s34, s40, 9
  s_add_u32 s34, s34, 8011776
  v_lshlrev_b32 v48, 3, v1
  buffer_load_dword v50, v48, s[16:19], s34 offen
  s_waitcnt vmcnt(9)
  s_barrier
  s_waitcnt vmcnt(3)
  s_barrier
  s_mul_i32 s20, s41, 3
  s_mul_i32 s3, s40, 3
  s_lshr_b32 s3, s3, 2
  s_add_u32 s3, s3, s51
  s_cmp_ge_u32 s3, 6
  s_cselect_b32 s34, 6, 0
  s_sub_u32 s3, s3, s34
  s_lshl_b32 s3, s3, 1
  s_add_u32 s3, s3, s20
  s_lshl_b32 s20, s20, 12
  s_add_u32 s20, s20, 49152
  s_cmp_ge_u32 s3, 12
  s_cselect_b32 s34, 12, 0
  s_sub_u32 s3, s3, s34
  s_lshl_b32 s34, s3, 12
  s_add_u32 s21, s69, s34
  s_add_u32 s3, s3, 1
  s_cmp_ge_u32 s3, 12
  s_cselect_b32 s34, 12, 0
  s_sub_u32 s3, s3, s34
  s_lshl_b32 s34, s3, 12
  s_add_u32 s22, s69, s34
  s_add_u32 s3, s3, 1
  s_cmp_ge_u32 s3, 12
  s_cselect_b32 s34, 12, 0
  s_sub_u32 s3, s3, s34
  s_lshl_b32 s34, s3, 12
  s_add_u32 s23, s69, s34
  s_add_u32 s3, s3, 1
  s_add_u32 s69, s69, 49152
  s_add_u32 s69, s69, s47
  s_cmp_lg_u32 s41, 0
  s_cbranch_scc1 A_ld2
  s_mov_b32 exec_lo, 0xf
  s_mov_b32 exec_hi, 0x0
  s_mov_b32 s35, 1048576
gp_8:
  buffer_load_dword v40, v38, s[16:19], s68 offen sc1
  s_waitcnt vmcnt(0)
  v_cmp_ne_u32 vcc, s44, v40
  s_cbranch_vccnz gr_9
gd_10:
  s_mov_b64 exec, -1
  s_sub_u32 s69, s69, 49152
  s_mov_b32 s68, s21
  s_sub_u32 s3, s21, s69
  s_mov_b32 m0, 49152
  s_nop 0
  buffer_load_dwordx4 v10, s[16:19], s68 offen offset:0 sc1 lds
  buffer_load_dwordx4 v10, s[16:19], s68 offen offset:1024 sc1 lds
  buffer_load_dwordx4 v10, s[16:19], s68 offen offset:2048 sc1 lds
  buffer_load_dwordx4 v10, s[16:19], s68 offen offset:3072 sc1 lds
  s_add_u32 s68, s68, 4096
  s_mov_b32 m0, 53248
  s_nop 0
  buffer_load_dwordx4 v10, s[16:19], s68 offen offset:0 sc1 lds
  buffer_load_dwordx4 v10, s[16:19], s68 offen offset:1024 sc1 lds
  buffer_load_dwordx4 v10, s[16:19], s68 offen offset:2048 sc1 lds
  buffer_load_dwordx4 v10, s[16:19], s68 offen offset:3072 sc1 lds
  s_add_u32 s3, s3, 8192
  s_cmp_ge_u32 s3, 49152
  s_cselect_b32 s3, 0, s3
  s_add_u32 s68, s69, s3
  s_mov_b32 m0, 57344
  s_nop 0
  buffer_load_dwordx4 v10, s[16:19], s68 offen offset:0 sc1 lds
  buffer_load_dwordx4 v10, s[16:19], s68 offen offset:1024 sc1 lds
  buffer_load_dwordx4 v10, s[16:19], s68 offen offset:2048 sc1 lds
  buffer_load_dwordx4 v10, s[16:19], s68 offen offset:3072 sc1 lds
  s_add_u32 s68, s68, 4096
  s_mov_b32 m0, 61440
  s_nop 0
  buffer_load_dwordx4 v10, s[16:19], s68 offen offset:0 sc1 lds
  buffer_load_dwordx4 v10, s[16:19], s68 offen offset:1024 sc1 lds
  buffer_load_dwordx4 v10, s[16:19], s68 offen offset:2048 sc1 lds
  buffer_load_dwordx4 v10, s[16:19], s68 offen offset:3072 sc1 lds
  s_add_u32 s3, s3, 8192
  s_cmp_ge_u32 s3, 49152
  s_cselect_b32 s3, 0, s3
  s_add_u32 s68, s69, s3
  s_mov_b32 m0, 65536
  s_nop 0
  buffer_load_dwordx4 v10, s[16:19], s68 offen offset:0 sc1 lds
  buffer_load_dwordx4 v10, s[16:19], s68 offen offset:1024 sc1 lds
  buffer_load_dwordx4 v10, s[16:19], s68 offen offset:2048 sc1 lds
  buffer_load_dwordx4 v10, s[16:19], s68 offen offset:3072 sc1 lds
  s_add_u32 s68, s68, 4096
  s_mov_b32 m0, 69632
  s_nop 0
  buffer_load_dwordx4 v10, s[16:19], s68 offen offset:0 sc1 lds
  buffer_load_dwordx4 v10, s[16:19], s68 offen offset:1024 sc1 lds
  buffer_load_dwordx4 v10, s[16:19], s68 offen offset:2048 sc1 lds
  buffer_load_dwordx4 v10, s[16:19], s68 offen offset:3072 sc1 lds
  s_add_u32 s3, s3, 8192
  s_cmp_ge_u32 s3, 49152
  s_cselect_b32 s3, 0, s3
  s_add_u32 s68, s69, s3
  s_mov_b32 m0, 73728
  s_nop 0
  buffer_load_dwordx4 v10, s[16:19], s68 offen offset:0 sc1 lds
  buffer_load_dwordx4 v10, s[16:19], s68 offen offset:1024 sc1 lds
  buffer_load_dwordx4 v10, s[16:19], s68 offen offset:2048 sc1 lds
  buffer_load_dwordx4 v10, s[16:19], s68 offen offset:3072 sc1 lds
  s_add_u32 s68, s68, 4096
  s_mov_b32 m0, 77824
  s_nop 0
  buffer_load_dwordx4 v10, s[16:19], s68 offen offset:0 sc1 lds
  buffer_load_dwordx4 v10, s[16:19], s68 offen offset:1024 sc1 lds
  buffer_load_dwordx4 v10, s[16:19], s68 offen offset:2048 sc1 lds
  buffer_load_dwordx4 v10, s[16:19], s68 offen offset:3072 sc1 lds
  s_add_u32 s3, s3, 8192
  s_cmp_ge_u32 s3, 49152
  s_cselect_b32 s3, 0, s3
  s_add_u32 s68, s69, s3
  s_mov_b32 m0, 81920
  s_nop 0
  buffer_load_dwordx4 v10, s[16:19], s68 offen offset:0 sc1 lds
  buffer_load_dwordx4 v10, s[16:19], s68 offen offset:1024 sc1 lds
  buffer_load_dwordx4 v10, s[16:19], s68 offen offset:2048 sc1 lds
  buffer_load_dwordx4 v10, s[16:19], s68 offen offset:3072 sc1 lds
  s_add_u32 s68, s68, 4096
  s_mov_b32 m0, 86016
  s_nop 0
  buffer_load_dwordx4 v10, s[16:19], s68 offen offset:0 sc1 lds
  buffer_load_dwordx4 v10, s[16:19], s68 offen offset:1024 sc1 lds
  buffer_load_dwordx4 v10, s[16:19], s68 offen offset:2048 sc1 lds
  buffer_load_dwordx4 v10, s[16:19], s68 offen offset:3072 sc1 lds
  s_add_u32 s3, s3, 8192
  s_cmp_ge_u32 s3, 49152
  s_cselect_b32 s3, 0, s3
  s_add_u32 s68, s69, s3
  s_mov_b32 m0, 90112
  s_nop 0
  buffer_load_dwordx4 v10, s[16:19], s68 offen offset:0 sc1 lds
  buffer_load_dwordx4 v10, s[16:19], s68 offen offset:1024 sc1 lds
  buffer_load_dwordx4 v10, s[16:19], s68 offen offset:2048 sc1 lds
  buffer_load_dwordx4 v10, s[16:19], s68 offen offset:3072 sc1 lds
  s_add_u32 s68, s68, 4096
  s_mov_b32 m0, 94208
  s_nop 0
  buffer_load_dwordx4 v10, s[16:19], s68 offen offset:0 sc1 lds
  buffer_load_dwordx4 v10, s[16:19], s68 offen offset:1024 sc1 lds
  buffer_load_dwordx4 v10, s[16:19], s68 offen offset:2048 sc1 lds
  buffer_load_dwordx4 v10, s[16:19], s68 offen offset:3072 sc1 lds
  s_add_u32 s68, s69, 49152
  s_mov_b32 m0, 98304
  s_nop 0
  buffer_load_dwordx4 v10, s[16:19], s68 offen offset:0 sc1 lds
  buffer_load_dwordx4 v10, s[16:19], s68 offen offset:1024 sc1 lds
  buffer_load_dwordx4 v10, s[16:19], s68 offen offset:2048 sc1 lds
  s_waitcnt vmcnt(35)
  s_barrier
  s_waitcnt vmcnt(15)
  s_branch A_ld3
A_ld2:
  s_barrier
A_ld3:
  s_barrier
  s_waitcnt vmcnt(0) lgkmcnt(0)
  s_barrier
  s_barrier
  s_branch P2_l
A_c:
  s_setprio 1
  s_lshl_b32 s47, s41, 10
  s_getreg_b32 s45, hwreg(HW_REG_XCC_ID)
  s_and_b32 s45, s45, 15
  s_add_u32 s45, s45, 1
  s_getpc_b64 s[48:49]
pc_1:
  s_sub_u32 s48, s48, pc_1-standalone__video_timesformer__vision_kernel
  s_subb_u32 s49, s49, 0
  s_lshl_b32 s34, s42, 2
  s_add_u32 s34, s34, s41
  s_and_b32 s34, s34, 31
  s_lshl_b32 s34, s34, 10
  v_lshl_add_u32 v9, v1, 4, s34
  global_load_dwordx4 v[252:255], v9, s[48:49]
  s_lshr_b32 s52, s41, 1
  s_and_b32 s53, s41, 1
  v_and_b32 v4, 31, v1
  v_lshrrev_b32 v5, 5, v1
  v_bfe_u32 v6, v1, 1, 3
  v_xor_b32 v6, v6, v5
  v_lshlrev_b32 v4, 7, v4
  v_lshl_add_u32 v4, v6, 4, v4
  s_lshl_b32 s35, s52, 12
  v_add_u32 v12, s35, v4
  v_xor_b32 v13, 32, v12
  v_xor_b32 v14, 64, v12
  v_xor_b32 v15, 96, v12
  v_bfe_u32 v6, v1, 2, 2
  v_lshl_add_u32 v4, v5, 3, v6
  v_lshlrev_b32 v4, 7, v4
  v_lshrrev_b32 v7, 1, v6
  v_xor_b32 v7, s53, v7
  v_lshl_add_u32 v4, v7, 6, v4
  v_bfe_u32 v7, v1, 4, 1
  v_lshl_add_u32 v4, v7, 5, v4
  v_and_b32 v8, 1, v1
  v_lshl_add_u32 v4, v8, 4, v4
  v_bfe_u32 v8, v1, 1, 1
  v_lshl_add_u32 v4, v8, 3, v4
  v_add_u32 v16, 49152, v4
  v_add_u32 v17, 114688, v4
  v_bfe_u32 v8, v1, 2, 1
  v_cmp_eq_u32 vcc, v8, v7
  v_mov_b32 v7, 0x3f803f80
  s_mov_b32 s34, 8077312
  s_waitcnt lgkmcnt(0)
  s_load_dword s44, s[32:33], s34
  v_cndmask_b32 v108, 0, v7, vcc
  v_cndmask_b32 v109, 0, v7, vcc
  v_cndmask_b32 v110, 0, v7, vcc
  v_cndmask_b32 v111, 0, v7, vcc
  s_mov_b32 s16, s32
  s_mov_b32 s17, s33
  s_mov_b32 s18, 16777216
  s_mov_b32 s19, 0x20000
  s_mov_b32 s24, s38
  s_mov_b32 s25, s39
  s_mov_b32 s26, 1572864
  s_mov_b32 s27, 0x20000
  v_lshlrev_b32 v18, 9, v5
  v_lshl_add_u32 v18, v3, 6, v18
  v_bfe_u32 v6, v1, 3, 2
  v_lshl_add_u32 v18, v6, 4, v18
  s_mul_i32 s34, s50, 24576
  s_lshl_b32 s35, s52, 10
  s_add_u32 s34, s34, s35
  s_add_u32 s57, s34, 1572864
  s_lshl_b32 s35, s51, 1
  s_add_u32 s35, s35, s53
  s_lshl_b32 s62, s35, 2
  s_lshl_b32 s36, s35, 11
  s_add_u32 s56, s57, s36
  s_lshl_b32 s34, s50, 1
  s_add_u32 s34, s34, s52
  s_lshl_b32 s34, s34, 7
  s_add_u32 s60, s34, 7995392
  s_add_u32 s61, s34, 8003584
  v_bfe_u32 v6, v1, 2, 3
  v_and_b32 v7, 3, v1
  s_mov_b32 s34, 196608
  v_mul_lo_u32 v19, v6, s34
  v_lshl_add_u32 v19, v5, 8, v19
  v_lshl_add_u32 v19, v7, 4, v19
  v_mul_u32_u24 v20, 49152, v6
  v_lshl_add_u32 v20, v7, 4, v20
  v_lshl_add_u32 v8, v7, 3, v6
  v_lshlrev_b32 v22, 2, v8
  v_lshlrev_b32 v23, 5, v7
  v_lshl_add_u32 v23, v5, 4, v23
  v_bfe_u32 v4, v8, 1, 3
  s_lshl_b32 s34, s53, 2
  v_xor_b32 v4, s34, v4
  v_xor_b32 v4, v4, v5
  v_lshlrev_b32 v4, 4, v4
  v_lshl_add_u32 v4, v8, 7, v4
  s_add_u32 s34, s51, 6
  s_sub_u32 s34, s34, s3
  s_cmp_ge_u32 s34, 6
  s_cselect_b32 s36, 6, 0
  s_sub_u32 s34, s34, s36
  s_lshl_b32 s34, s34, 13
  s_lshl_b32 s36, s52, 12
  s_add_u32 s34, s34, s36
  v_add_u32 v21, s34, v4
  s_lshl_b32 s34, s53, 10
  s_add_u32 s34, s34, 49152
  v_add_u32 v24, s34, v10
  v_and_b32 v4, 31, v1
  v_lshlrev_b32 v4, 2, v4
  s_lshl_b32 s34, s53, 7
  s_add_u32 s34, s34, 98304
  v_add_u32 v4, s34, v4
  v_lshl_add_u32 v25, v5, 10, v4
  v_add_u32 v26, 2048, v4
  s_lshr_b32 s34, s50, 1
  s_mul_i32 s34, s34, 12288
  s_lshl_b32 s36, s35, 10
  s_add_u32 s34, s34, s36
  s_and_b32 s36, s50, 1
  s_lshl_b32 s36, s36, 7
  s_add_u32 s34, s34, s36
  s_lshl_b32 s36, s52, 6
  s_add_u32 s34, s34, s36
  s_add_u32 s58, s34, 2359296
  s_lshl_b32 s34, s35, 12
  s_add_u32 s34, s34, s36
  s_lshl_b32 s36, s50, 7
  s_add_u32 s34, s34, s36
  s_add_u32 s59, s34, 15728640
  s_mul_i32 s34, s50, 6
  s_add_u32 s34, s34, s51
  s_lshl_b32 s63, s34, 7
  s_mov_b32 s38, 0xbb2aaaab
  s_mov_b32 s36, 0xffff0000
  s_mov_b32 s64, -1
  s_mov_b32 s65, 0
  s_mov_b32 s66, 0xff00ff00
  s_mov_b32 s67, 0xff00ff00
  s_mov_b32 s68, 0xffff0000
  s_mov_b32 s69, 0xffff0000
  v_mov_b32 v113, 0
  v_mov_b32 v114, 0
  v_mov_b32 v115, 0
  v_mov_b32 v117, 0
  v_mov_b32 v118, 0
  v_mov_b32 v119, 0
  s_waitcnt lgkmcnt(0)
  s_mul_i32 s44, s44, 0x9e3779b1
  s_add_u32 s44, s44, 0x7f4a7c15
  s_add_u32 s45, s45, s44
  s_barrier
  ds_read_b128 v[160:163], v12 offset:0
  ds_read_b64_tr_b16 v[32:33], v16 offset:0
  ds_read_b64_tr_b16 v[34:35], v16 offset:512
  ds_read_b64_tr_b16 v[36:37], v16 offset:8192
  ds_read_b64_tr_b16 v[38:39], v16 offset:8704
  ds_read_b128 v[164:167], v13 offset:0
  ds_read_b64_tr_b16 v[40:41], v16 offset:2048
  ds_read_b64_tr_b16 v[42:43], v16 offset:2560
  ds_read_b64_tr_b16 v[44:45], v16 offset:10240
  ds_read_b64_tr_b16 v[46:47], v16 offset:10752
  s_waitcnt lgkmcnt(5)
  v_mfma_f32_32x32x16_bf16 v[64:79], v[32:35], v[160:163], 0
  ds_read_b128 v[168:171], v14 offset:0
  ds_read_b64_tr_b16 v[48:49], v16 offset:4096
  ds_read_b64_tr_b16 v[50:51], v16 offset:4608
  v_mfma_f32_16x16x32_bf16 v[96:99], v[108:111], v[32:35], 0
  v_mfma_f32_32x32x16_bf16 v[80:95], v[36:39], v[160:163], 0
  ds_read_b64_tr_b16 v[52:53], v16 offset:12288
  ds_read_b64_tr_b16 v[54:55], v16 offset:12800
  v_mfma_f32_16x16x32_bf16 v[100:103], v[108:111], v[36:39], 0
  v_mfma_f32_16x16x32_bf16 v[104:107], v[108:111], v[160:163], 0
  s_waitcnt lgkmcnt(5)
  v_mfma_f32_32x32x16_bf16 v[64:79], v[40:43], v[164:167], v[64:79]
  ds_read_b128 v[172:175], v15 offset:0
  ds_read_b64_tr_b16 v[32:33], v16 offset:6144
  ds_read_b64_tr_b16 v[34:35], v16 offset:6656
  v_mfma_f32_16x16x32_bf16 v[96:99], v[108:111], v[40:43], v[96:99]
  v_mfma_f32_32x32x16_bf16 v[80:95], v[44:47], v[164:167], v[80:95]
  ds_read_b64_tr_b16 v[36:37], v16 offset:14336
  ds_read_b64_tr_b16 v[38:39], v16 offset:14848
  v_mfma_f32_16x16x32_bf16 v[100:103], v[108:111], v[44:47], v[100:103]
  v_mfma_f32_16x16x32_bf16 v[104:107], v[108:111], v[164:167], v[104:107]
  s_waitcnt lgkmcnt(5)
  v_mfma_f32_32x32x16_bf16 v[64:79], v[48:51], v[168:171], v[64:79]
  v_mfma_f32_16x16x32_bf16 v[96:99], v[108:111], v[48:51], v[96:99]
  v_mfma_f32_32x32x16_bf16 v[80:95], v[52:55], v[168:171], v[80:95]
  v_mfma_f32_16x16x32_bf16 v[100:103], v[108:111], v[52:55], v[100:103]
  v_mfma_f32_16x16x32_bf16 v[104:107], v[108:111], v[168:171], v[104:107]
  s_barrier
  ds_read_b128 v[176:179], v12 offset:8192
  ds_read_b64_tr_b16 v[40:41], v16 offset:16384
  ds_read_b64_tr_b16 v[42:43], v16 offset:16896
  ds_read_b64_tr_b16 v[44:45], v16 offset:24576
  ds_read_b64_tr_b16 v[46:47], v16 offset:25088
  s_waitcnt lgkmcnt(5)
  v_mfma_f32_32x32x16_bf16 v[64:79], v[32:35], v[172:175], v[64:79]
  ds_read_b128 v[180:183], v13 offset:8192
  ds_read_b64_tr_b16 v[48:49], v16 offset:18432
  ds_read_b64_tr_b16 v[50:51], v16 offset:18944
  v_mfma_f32_16x16x32_bf16 v[96:99], v[108:111], v[32:35], v[96:99]
  v_mfma_f32_32x32x16_bf16 v[80:95], v[36:39], v[172:175], v[80:95]
  ds_read_b64_tr_b16 v[52:53], v16 offset:26624
  ds_read_b64_tr_b16 v[54:55], v16 offset:27136
  v_mfma_f32_16x16x32_bf16 v[100:103], v[108:111], v[36:39], v[100:103]
  v_mfma_f32_16x16x32_bf16 v[104:107], v[108:111], v[172:175], v[104:107]
  s_waitcnt lgkmcnt(5)
  v_mfma_f32_32x32x16_bf16 v[64:79], v[40:43], v[176:179], v[64:79]
  ds_read_b128 v[184:187], v14 offset:8192
  ds_read_b64_tr_b16 v[32:33], v16 offset:20480
  ds_read_b64_tr_b16 v[34:35], v16 offset:20992
  v_mfma_f32_16x16x32_bf16 v[96:99], v[108:111], v[40:43], v[96:99]
  v_mfma_f32_32x32x16_bf16 v[80:95], v[44:47], v[176:179], v[80:95]
  ds_read_b64_tr_b16 v[36:37], v16 offset:28672
  ds_read_b64_tr_b16 v[38:39], v16 offset:29184
  v_mfma_f32_16x16x32_bf16 v[100:103], v[108:111], v[44:47], v[100:103]
  v_mfma_f32_16x16x32_bf16 v[104:107], v[108:111], v[176:179], v[104:107]
  s_waitcnt lgkmcnt(5)
  v_mfma_f32_32x32x16_bf16 v[64:79], v[48:51], v[180:183], v[64:79]
  ds_read_b128 v[188:191], v15 offset:8192
  ds_read_b64_tr_b16 v[40:41], v16 offset:22528
  ds_read_b64_tr_b16 v[42:43], v16 offset:23040
  v_mfma_f32_16x16x32_bf16 v[96:99], v[108:111], v[48:51], v[96:99]
  v_mfma_f32_32x32x16_bf16 v[80:95], v[52:55], v[180:183], v[80:95]
  ds_read_b64_tr_b16 v[44:45], v16 offset:30720
  ds_read_b64_tr_b16 v[46:47], v16 offset:31232
  v_mfma_f32_16x16x32_bf16 v[100:103], v[108:111], v[52:55], v[100:103]
  v_mfma_f32_16x16x32_bf16 v[104:107], v[108:111], v[180:183], v[104:107]
  s_waitcnt lgkmcnt(5)
  v_mfma_f32_32x32x16_bf16 v[64:79], v[32:35], v[184:187], v[64:79]
  v_mfma_f32_16x16x32_bf16 v[96:99], v[108:111], v[32:35], v[96:99]
  v_mfma_f32_32x32x16_bf16 v[80:95], v[36:39], v[184:187], v[80:95]
  v_mfma_f32_16x16x32_bf16 v[100:103], v[108:111], v[36:39], v[100:103]
  v_mfma_f32_16x16x32_bf16 v[104:107], v[108:111], v[184:187], v[104:107]
  s_barrier
  ds_read_b128 v[192:195], v12 offset:16384
  ds_read_b64_tr_b16 v[48:49], v16 offset:32768
  ds_read_b64_tr_b16 v[50:51], v16 offset:33280
  ds_read_b64_tr_b16 v[52:53], v16 offset:40960
  ds_read_b64_tr_b16 v[54:55], v16 offset:41472
  s_waitcnt lgkmcnt(5)
  v_mfma_f32_32x32x16_bf16 v[64:79], v[40:43], v[188:191], v[64:79]
  ds_read_b128 v[196:199], v13 offset:16384
  ds_read_b64_tr_b16 v[32:33], v16 offset:34816
  ds_read_b64_tr_b16 v[34:35], v16 offset:35328
  v_mfma_f32_16x16x32_bf16 v[96:99], v[108:111], v[40:43], v[96:99]
  v_mfma_f32_32x32x16_bf16 v[80:95], v[44:47], v[188:191], v[80:95]
  ds_read_b64_tr_b16 v[36:37], v16 offset:43008
  ds_read_b64_tr_b16 v[38:39], v16 offset:43520
  v_mfma_f32_16x16x32_bf16 v[100:103], v[108:111], v[44:47], v[100:103]
  v_mfma_f32_16x16x32_bf16 v[104:107], v[108:111], v[188:191], v[104:107]
  s_waitcnt lgkmcnt(5)
  v_mfma_f32_32x32x16_bf16 v[64:79], v[48:51], v[192:195], v[64:79]
  ds_read_b128 v[200:203], v14 offset:16384
  ds_read_b64_tr_b16 v[40:41], v16 offset:36864
  ds_read_b64_tr_b16 v[42:43], v16 offset:37376
  v_mfma_f32_16x16x32_bf16 v[96:99], v[108:111], v[48:51], v[96:99]
  v_mfma_f32_32x32x16_bf16 v[80:95], v[52:55], v[192:195], v[80:95]
  ds_read_b64_tr_b16 v[44:45], v16 offset:45056
  ds_read_b64_tr_b16 v[46:47], v16 offset:45568
  v_mfma_f32_16x16x32_bf16 v[100:103], v[108:111], v[52:55], v[100:103]
  v_mfma_f32_16x16x32_bf16 v[104:107], v[108:111], v[192:195], v[104:107]
  s_waitcnt lgkmcnt(5)
  v_mfma_f32_32x32x16_bf16 v[64:79], v[32:35], v[196:199], v[64:79]
  ds_read_b128 v[204:207], v15 offset:16384
  ds_read_b64_tr_b16 v[48:49], v16 offset:38912
  ds_read_b64_tr_b16 v[50:51], v16 offset:39424
  v_mfma_f32_16x16x32_bf16 v[96:99], v[108:111], v[32:35], v[96:99]
  v_mfma_f32_32x32x16_bf16 v[80:95], v[36:39], v[196:199], v[80:95]
  ds_read_b64_tr_b16 v[52:53], v16 offset:47104
  ds_read_b64_tr_b16 v[54:55], v16 offset:47616
  v_mfma_f32_16x16x32_bf16 v[100:103], v[108:111], v[36:39], v[100:103]
  v_mfma_f32_16x16x32_bf16 v[104:107], v[108:111], v[196:199], v[104:107]
  s_waitcnt lgkmcnt(5)
  v_mfma_f32_32x32x16_bf16 v[64:79], v[40:43], v[200:203], v[64:79]
  v_mfma_f32_16x16x32_bf16 v[96:99], v[108:111], v[40:43], v[96:99]
  v_mfma_f32_32x32x16_bf16 v[80:95], v[44:47], v[200:203], v[80:95]
  v_mfma_f32_16x16x32_bf16 v[100:103], v[108:111], v[44:47], v[100:103]
  v_mfma_f32_16x16x32_bf16 v[104:107], v[108:111], v[200:203], v[104:107]
  s_barrier
  ds_read_b128 v[208:211], v12 offset:24576
  ds_read_b64_tr_b16 v[32:33], v16 offset:49152
  ds_read_b64_tr_b16 v[34:35], v16 offset:49664
  ds_read_b64_tr_b16 v[36:37], v16 offset:57344
  ds_read_b64_tr_b16 v[38:39], v16 offset:57856
  s_waitcnt lgkmcnt(5)
  v_mfma_f32_32x32x16_bf16 v[64:79], v[48:51], v[204:207], v[64:79]
  ds_read_b128 v[212:215], v13 offset:24576
  ds_read_b64_tr_b16 v[40:41], v16 offset:51200
  ds_read_b64_tr_b16 v[42:43], v16 offset:51712
  v_mfma_f32_16x16x32_bf16 v[96:99], v[108:111], v[48:51], v[96:99]
  v_mfma_f32_32x32x16_bf16 v[80:95], v[52:55], v[204:207], v[80:95]
  ds_read_b64_tr_b16 v[44:45], v16 offset:59392
  ds_read_b64_tr_b16 v[46:47], v16 offset:59904
  v_mfma_f32_16x16x32_bf16 v[100:103], v[108:111], v[52:55], v[100:103]
  v_mfma_f32_16x16x32_bf16 v[104:107], v[108:111], v[204:207], v[104:107]
  s_waitcnt lgkmcnt(5)
  v_mfma_f32_32x32x16_bf16 v[64:79], v[32:35], v[208:211], v[64:79]
  ds_read_b128 v[216:219], v14 offset:24576
  ds_read_b64_tr_b16 v[48:49], v16 offset:53248
  ds_read_b64_tr_b16 v[50:51], v16 offset:53760
  v_mfma_f32_16x16x32_bf16 v[96:99], v[108:111], v[32:35], v[96:99]
  v_mfma_f32_32x32x16_bf16 v[80:95], v[36:39], v[208:211], v[80:95]
  ds_read_b64_tr_b16 v[52:53], v16 offset:61440
  ds_read_b64_tr_b16 v[54:55], v16 offset:61952
  v_mfma_f32_16x16x32_bf16 v[100:103], v[108:111], v[36:39], v[100:103]
  v_mfma_f32_16x16x32_bf16 v[104:107], v[108:111], v[208:211], v[104:107]
  s_waitcnt lgkmcnt(5)
  v_mfma_f32_32x32x16_bf16 v[64:79], v[40:43], v[212:215], v[64:79]
  ds_read_b128 v[220:223], v15 offset:24576
  ds_read_b64_tr_b16 v[32:33], v16 offset:55296
  ds_read_b64_tr_b16 v[34:35], v16 offset:55808
  v_mfma_f32_16x16x32_bf16 v[96:99], v[108:111], v[40:43], v[96:99]
  v_mfma_f32_32x32x16_bf16 v[80:95], v[44:47], v[212:215], v[80:95]
  ds_read_b64_tr_b16 v[36:37], v16 offset:63488
  ds_read_b64_tr_b16 v[38:39], v16 offset:64000
  v_mfma_f32_16x16x32_bf16 v[100:103], v[108:111], v[44:47], v[100:103]
  v_mfma_f32_16x16x32_bf16 v[104:107], v[108:111], v[212:215], v[104:107]
  s_waitcnt lgkmcnt(5)
  v_mfma_f32_32x32x16_bf16 v[64:79], v[48:51], v[216:219], v[64:79]
  v_mfma_f32_16x16x32_bf16 v[96:99], v[108:111], v[48:51], v[96:99]
  v_mfma_f32_32x32x16_bf16 v[80:95], v[52:55], v[216:219], v[80:95]
  v_mfma_f32_16x16x32_bf16 v[100:103], v[108:111], v[52:55], v[100:103]
  v_mfma_f32_16x16x32_bf16 v[104:107], v[108:111], v[216:219], v[104:107]
  s_waitcnt vmcnt(0)
  s_barrier
  ds_read_b128 v[224:227], v12 offset:32768
  ds_read_b64_tr_b16 v[40:41], v17 offset:0
  ds_read_b64_tr_b16 v[42:43], v17 offset:512
  ds_read_b64_tr_b16 v[44:45], v17 offset:8192
  ds_read_b64_tr_b16 v[46:47], v17 offset:8704
  s_waitcnt lgkmcnt(5)
  v_mfma_f32_32x32x16_bf16 v[64:79], v[32:35], v[220:223], v[64:79]
  ds_read_b128 v[228:231], v13 offset:32768
  ds_read_b64_tr_b16 v[48:49], v17 offset:2048
  ds_read_b64_tr_b16 v[50:51], v17 offset:2560
  v_mfma_f32_16x16x32_bf16 v[96:99], v[108:111], v[32:35], v[96:99]
  v_mfma_f32_32x32x16_bf16 v[80:95], v[36:39], v[220:223], v[80:95]
  ds_read_b64_tr_b16 v[52:53], v17 offset:10240
  ds_read_b64_tr_b16 v[54:55], v17 offset:10752
  v_mfma_f32_16x16x32_bf16 v[100:103], v[108:111], v[36:39], v[100:103]
  v_mfma_f32_16x16x32_bf16 v[104:107], v[108:111], v[220:223], v[104:107]
  s_waitcnt lgkmcnt(5)
  v_mfma_f32_32x32x16_bf16 v[64:79], v[40:43], v[224:227], v[64:79]
  ds_read_b128 v[232:235], v14 offset:32768
  ds_read_b64_tr_b16 v[32:33], v17 offset:4096
  ds_read_b64_tr_b16 v[34:35], v17 offset:4608
  v_mfma_f32_16x16x32_bf16 v[96:99], v[108:111], v[40:43], v[96:99]
  v_mfma_f32_32x32x16_bf16 v[80:95], v[44:47], v[224:227], v[80:95]
  ds_read_b64_tr_b16 v[36:37], v17 offset:12288
  ds_read_b64_tr_b16 v[38:39], v17 offset:12800
  v_mfma_f32_16x16x32_bf16 v[100:103], v[108:111], v[44:47], v[100:103]
  v_mfma_f32_16x16x32_bf16 v[104:107], v[108:111], v[224:227], v[104:107]
  s_waitcnt lgkmcnt(5)
  v_mfma_f32_32x32x16_bf16 v[64:79], v[48:51], v[228:231], v[64:79]
  ds_read_b128 v[236:239], v15 offset:32768
  ds_read_b64_tr_b16 v[40:41], v17 offset:6144
  ds_read_b64_tr_b16 v[42:43], v17 offset:6656
  v_mfma_f32_16x16x32_bf16 v[96:99], v[108:111], v[48:51], v[96:99]
  v_mfma_f32_32x32x16_bf16 v[80:95], v[52:55], v[228:231], v[80:95]
  ds_read_b64_tr_b16 v[44:45], v17 offset:14336
  ds_read_b64_tr_b16 v[46:47], v17 offset:14848
  v_mfma_f32_16x16x32_bf16 v[100:103], v[108:111], v[52:55], v[100:103]
  v_mfma_f32_16x16x32_bf16 v[104:107], v[108:111], v[228:231], v[104:107]
  s_waitcnt lgkmcnt(5)
  v_mfma_f32_32x32x16_bf16 v[64:79], v[32:35], v[232:235], v[64:79]
  v_mfma_f32_16x16x32_bf16 v[96:99], v[108:111], v[32:35], v[96:99]
  v_mfma_f32_32x32x16_bf16 v[80:95], v[36:39], v[232:235], v[80:95]
  v_mfma_f32_16x16x32_bf16 v[100:103], v[108:111], v[36:39], v[100:103]
  v_mfma_f32_16x16x32_bf16 v[104:107], v[108:111], v[232:235], v[104:107]
  s_barrier
  ds_read_b128 v[240:243], v12 offset:40960
  ds_read_b64_tr_b16 v[48:49], v17 offset:16384
  ds_read_b64_tr_b16 v[50:51], v17 offset:16896
  ds_read_b64_tr_b16 v[52:53], v17 offset:24576
  ds_read_b64_tr_b16 v[54:55], v17 offset:25088
  s_waitcnt lgkmcnt(5)
  v_mfma_f32_32x32x16_bf16 v[64:79], v[40:43], v[236:239], v[64:79]
  ds_read_b128 v[244:247], v13 offset:40960
  ds_read_b64_tr_b16 v[32:33], v17 offset:18432
  ds_read_b64_tr_b16 v[34:35], v17 offset:18944
  v_mfma_f32_16x16x32_bf16 v[96:99], v[108:111], v[40:43], v[96:99]
  v_mfma_f32_32x32x16_bf16 v[80:95], v[44:47], v[236:239], v[80:95]
  ds_read_b64_tr_b16 v[36:37], v17 offset:26624
  ds_read_b64_tr_b16 v[38:39], v17 offset:27136
  v_mfma_f32_16x16x32_bf16 v[100:103], v[108:111], v[44:47], v[100:103]
  v_mfma_f32_16x16x32_bf16 v[104:107], v[108:111], v[236:239], v[104:107]
  s_waitcnt lgkmcnt(5)
  v_mfma_f32_32x32x16_bf16 v[64:79], v[48:51], v[240:243], v[64:79]
  ds_read_b128 v[248:251], v14 offset:40960
  ds_read_b64_tr_b16 v[40:41], v17 offset:20480
  ds_read_b64_tr_b16 v[42:43], v17 offset:20992
  v_mfma_f32_16x16x32_bf16 v[96:99], v[108:111], v[48:51], v[96:99]
  v_mfma_f32_32x32x16_bf16 v[80:95], v[52:55], v[240:243], v[80:95]
  ds_read_b64_tr_b16 v[44:45], v17 offset:28672
  ds_read_b64_tr_b16 v[46:47], v17 offset:29184
  v_mfma_f32_16x16x32_bf16 v[100:103], v[108:111], v[52:55], v[100:103]
  v_mfma_f32_16x16x32_bf16 v[104:107], v[108:111], v[240:243], v[104:107]
  s_waitcnt lgkmcnt(5)
  v_mfma_f32_32x32x16_bf16 v[64:79], v[32:35], v[244:247], v[64:79]
  ds_read_b128 v[252:255], v15 offset:40960
  ds_read_b64_tr_b16 v[48:49], v17 offset:22528
  ds_read_b64_tr_b16 v[50:51], v17 offset:23040
  v_mfma_f32_16x16x32_bf16 v[96:99], v[108:111], v[32:35], v[96:99]
  v_mfma_f32_32x32x16_bf16 v[80:95], v[36:39], v[244:247], v[80:95]
  ds_read_b64_tr_b16 v[52:53], v17 offset:30720
  ds_read_b64_tr_b16 v[54:55], v17 offset:31232
  v_mfma_f32_16x16x32_bf16 v[100:103], v[108:111], v[36:39], v[100:103]
  v_mfma_f32_16x16x32_bf16 v[104:107], v[108:111], v[244:247], v[104:107]
  s_waitcnt lgkmcnt(5)
  v_mfma_f32_32x32x16_bf16 v[64:79], v[40:43], v[248:251], v[64:79]
  v_mfma_f32_16x16x32_bf16 v[96:99], v[108:111], v[40:43], v[96:99]
  v_mfma_f32_32x32x16_bf16 v[80:95], v[44:47], v[248:251], v[80:95]
  v_mfma_f32_16x16x32_bf16 v[100:103], v[108:111], v[44:47], v[100:103]
  v_mfma_f32_16x16x32_bf16 v[104:107], v[108:111], v[248:251], v[104:107]
  s_waitcnt lgkmcnt(0)
  v_mfma_f32_16x16x32_bf16 v[104:107], v[108:111], v[252:255], v[104:107]
  v_mfma_f32_16x16x32_bf16 v[96:99], v[108:111], v[48:51], v[96:99]
  v_mfma_f32_16x16x32_bf16 v[100:103], v[108:111], v[52:55], v[100:103]
  v_mfma_f32_32x32x16_bf16 v[64:79], v[48:51], v[252:255], v[64:79]
  v_mfma_f32_32x32x16_bf16 v[80:95], v[52:55], v[252:255], v[80:95]
  s_nop 3
  v_mul_f32 v104, s38, v104
  v_cvt_pk_bf16_f32 v112, v96, v96
  v_cvt_pk_bf16_f32 v116, v100, v100
  v_cvt_pk_bf16_f32 v105, v104, v104
  v_and_b32 v112, s36, v112
  v_and_b32 v116, s36, v116
  v_cndmask_b32 v120, 0, v105, s[64:65]
  v_sub_f32 v112, v96, v112
  v_sub_f32 v116, v100, v116
  v_mov_b32 v121, v120
  v_cvt_pk_bf16_f32 v112, v96, v112
  v_cvt_pk_bf16_f32 v116, v100, v116
  v_mov_b32 v122, v120
  v_mov_b32 v123, v120
  s_nop 1
  v_mfma_f32_32x32x16_bf16 v[64:79], v[112:115], v[120:123], v[64:79]
  v_mfma_f32_32x32x16_bf16 v[80:95], v[116:119], v[120:123], v[80:95]
  v_mov_b32 v100, 0
  v_mov_b32 v101, 0
  v_mov_b32 v124, v105
  v_mov_b32 v125, v105
  v_mov_b32 v126, v105
  v_mov_b32 v127, v105
  s_nop 4
  v_cvt_pk_bf16_f32 v32, v64, v65
  v_cvt_pk_bf16_f32 v33, v66, v67
  v_cvt_pk_bf16_f32 v34, v68, v69
  v_cvt_pk_bf16_f32 v35, v70, v71
  v_cvt_pk_bf16_f32 v36, v72, v73
  v_cvt_pk_bf16_f32 v37, v74, v75
  v_cvt_pk_bf16_f32 v38, v76, v77
  v_cvt_pk_bf16_f32 v39, v78, v79
  v_cvt_pk_bf16_f32 v40, v80, v81
  v_cvt_pk_bf16_f32 v41, v82, v83
  v_cvt_pk_bf16_f32 v42, v84, v85
  v_cvt_pk_bf16_f32 v43, v86, v87
  v_cvt_pk_bf16_f32 v44, v88, v89
  v_cvt_pk_bf16_f32 v45, v90, v91
  v_cvt_pk_bf16_f32 v46, v92, v93
  v_cvt_pk_bf16_f32 v47, v94, v95
  v_mfma_f32_32x32x16_bf16 v[64:79], v[40:43], v[32:35], 0
  s_nop 0
  v_mfma_f32_32x32x16_bf16 v[64:79], v[44:47], v[36:39], v[64:79]
  v_xor_b32 v4, 32, v21
  ds_read_b128 v[48:51], v21
  ds_read_b128 v[52:55], v4
  s_nop 8
  v_cndmask_b32 v64, v64, v68, s[66:67]
  v_cndmask_b32 v72, v72, v76, s[66:67]
  v_cndmask_b32 v65, v65, v69, s[66:67]
  v_cndmask_b32 v73, v73, v77, s[66:67]
  v_cndmask_b32 v66, v66, v70, s[66:67]
  v_cndmask_b32 v74, v74, v78, s[66:67]
  v_cndmask_b32 v67, v67, v71, s[66:67]
  v_cndmask_b32 v75, v75, v79, s[66:67]
  v_cndmask_b32 v96, v64, v72, s[68:69]
  v_cndmask_b32 v97, v65, v73, s[68:69]
  v_cndmask_b32 v98, v66, v74, s[68:69]
  v_cndmask_b32 v99, v67, v75, s[68:69]
  buffer_store_dwordx4 v[96:99], v18, s[16:19], s56 offen
  v_dot2c_f32_bf16 v100, v160, v160
  v_dot2c_f32_bf16 v101, v161, v161
  v_dot2c_f32_bf16 v100, v162, v162
  v_dot2c_f32_bf16 v101, v163, v163
  v_dot2c_f32_bf16 v100, v164, v164
  v_dot2c_f32_bf16 v101, v165, v165
  v_dot2c_f32_bf16 v100, v166, v166
  v_dot2c_f32_bf16 v101, v167, v167
  v_dot2c_f32_bf16 v100, v168, v168
  v_dot2c_f32_bf16 v101, v169, v169
  v_dot2c_f32_bf16 v100, v170, v170
  v_dot2c_f32_bf16 v101, v171, v171
  v_dot2c_f32_bf16 v100, v172, v172
  v_dot2c_f32_bf16 v101, v173, v173
  v_dot2c_f32_bf16 v100, v174, v174
  v_dot2c_f32_bf16 v101, v175, v175
  v_dot2c_f32_bf16 v100, v176, v176
  v_dot2c_f32_bf16 v101, v177, v177
  v_dot2c_f32_bf16 v100, v178, v178
  v_dot2c_f32_bf16 v101, v179, v179
  v_dot2c_f32_bf16 v100, v180, v180
  v_dot2c_f32_bf16 v101, v181, v181
  v_dot2c_f32_bf16 v100, v182, v182
  v_dot2c_f32_bf16 v101, v183, v183
  v_dot2c_f32_bf16 v100, v184, v184
  v_dot2c_f32_bf16 v101, v185, v185
  v_dot2c_f32_bf16 v100, v186, v186
  v_dot2c_f32_bf16 v101, v187, v187
  v_dot2c_f32_bf16 v100, v188, v188
  v_dot2c_f32_bf16 v101, v189, v189
  v_dot2c_f32_bf16 v100, v190, v190
  v_dot2c_f32_bf16 v101, v191, v191
  v_dot2c_f32_bf16 v100, v192, v192
  v_dot2c_f32_bf16 v101, v193, v193
  v_dot2c_f32_bf16 v100, v194, v194
  v_dot2c_f32_bf16 v101, v195, v195
  v_dot2c_f32_bf16 v100, v196, v196
  v_dot2c_f32_bf16 v101, v197, v197
  v_dot2c_f32_bf16 v100, v198, v198
  v_dot2c_f32_bf16 v101, v199, v199
  v_dot2c_f32_bf16 v100, v200, v200
  v_dot2c_f32_bf16 v101, v201, v201
  v_dot2c_f32_bf16 v100, v202, v202
  v_dot2c_f32_bf16 v101, v203, v203
  v_dot2c_f32_bf16 v100, v204, v204
  v_dot2c_f32_bf16 v101, v205, v205
  v_dot2c_f32_bf16 v100, v206, v206
  v_dot2c_f32_bf16 v101, v207, v207
  v_dot2c_f32_bf16 v100, v208, v208
  v_dot2c_f32_bf16 v101, v209, v209
  v_dot2c_f32_bf16 v100, v210, v210
  v_dot2c_f32_bf16 v101, v211, v211
  v_dot2c_f32_bf16 v100, v212, v212
  v_dot2c_f32_bf16 v101, v213, v213
  v_dot2c_f32_bf16 v100, v214, v214
  v_dot2c_f32_bf16 v101, v215, v215
  v_dot2c_f32_bf16 v100, v216, v216
  v_dot2c_f32_bf16 v101, v217, v217
  v_dot2c_f32_bf16 v100, v218, v218
  v_dot2c_f32_bf16 v101, v219, v219
  v_dot2c_f32_bf16 v100, v220, v220
  v_dot2c_f32_bf16 v101, v221, v221
  v_dot2c_f32_bf16 v100, v222, v222
  v_dot2c_f32_bf16 v101, v223, v223
  v_dot2c_f32_bf16 v100, v224, v224
  v_dot2c_f32_bf16 v101, v225, v225
  v_dot2c_f32_bf16 v100, v226, v226
  v_dot2c_f32_bf16 v101, v227, v227
  v_dot2c_f32_bf16 v100, v228, v228
  v_dot2c_f32_bf16 v101, v229, v229
  v_dot2c_f32_bf16 v100, v230, v230
  v_dot2c_f32_bf16 v101, v231, v231
  s_waitcnt vmcnt(0)
  s_mov_b64 exec, 1
  v_mov_b32 v4, s62
  v_mov_b32 v5, s45
  buffer_store_dword v5, v4, s[16:19], s60 offen
  s_mov_b64 exec, -1
  v_dot2c_f32_bf16 v100, v232, v232
  v_dot2c_f32_bf16 v101, v233, v233
  v_dot2c_f32_bf16 v100, v234, v234
  v_dot2c_f32_bf16 v101, v235, v235
  v_dot2c_f32_bf16 v100, v236, v236
  v_dot2c_f32_bf16 v101, v237, v237
  v_dot2c_f32_bf16 v100, v238, v238
  v_dot2c_f32_bf16 v101, v239, v239
  v_dot2c_f32_bf16 v100, v240, v240
  v_dot2c_f32_bf16 v101, v241, v241
  v_dot2c_f32_bf16 v100, v242, v242
  v_dot2c_f32_bf16 v101, v243, v243
  v_dot2c_f32_bf16 v100, v244, v244
  v_dot2c_f32_bf16 v101, v245, v245
  v_dot2c_f32_bf16 v100, v246, v246
  v_dot2c_f32_bf16 v101, v247, v247
  v_dot2c_f32_bf16 v100, v248, v248
  v_dot2c_f32_bf16 v101, v249, v249
  v_dot2c_f32_bf16 v100, v250, v250
  v_dot2c_f32_bf16 v101, v251, v251
  v_dot2c_f32_bf16 v100, v252, v252
  v_dot2c_f32_bf16 v101, v253, v253
  v_dot2c_f32_bf16 v100, v254, v254
  v_dot2c_f32_bf16 v101, v255, v255
  s_mov_b32 s37, 0x3727c5ac
  v_mul_f32 v102, v104, v104
  v_add_u32 v5, 4, v23
  v_add_f32 v100, v100, v101
  v_mov_b32 v101, v100
  v_add_u32 v6, 8, v23
  v_add_u32 v7, 12, v23
  v_permlane32_swap_b32 v100, v101
  v_add_f32 v100, v100, v101
  v_fma_f32 v100, -v100, s38, -v102
  v_max_f32 v100, 0, v100
  v_add_f32 v100, s37, v100
  v_rsq_f32 v100, v100
  ds_bpermute_b32 v60, v22, v100
  ds_bpermute_b32 v56, v23, v100
  ds_bpermute_b32 v57, v5, v100
  ds_bpermute_b32 v58, v6, v100
  ds_bpermute_b32 v59, v7, v100
  s_waitcnt lgkmcnt(5)
  v_lshlrev_b32 v80, 16, v48
  v_and_b32 v81, s36, v48
  v_lshlrev_b32 v82, 16, v49
  v_and_b32 v83, s36, v49
  v_lshlrev_b32 v84, 16, v50
  v_and_b32 v85, s36, v50
  v_lshlrev_b32 v86, 16, v51
  v_and_b32 v87, s36, v51
  v_lshlrev_b32 v88, 16, v52
  v_and_b32 v89, s36, v52
  v_lshlrev_b32 v90, 16, v53
  v_and_b32 v91, s36, v53
  v_lshlrev_b32 v92, 16, v54
  v_and_b32 v93, s36, v54
  v_lshlrev_b32 v94, 16, v55
  v_and_b32 v95, s36, v55
  s_waitcnt lgkmcnt(0)
  v_mul_f32 v60, 0x3d96c740, v60
  s_mov_b32 exec_lo, 0xfff
  s_mov_b32 exec_hi, 0x0
  v_lshlrev_b32 v32, 2, v1
  s_mov_b32 s46, 0
  s_mov_b32 s35, 24
lp_2:
  buffer_load_dword v34, v32, s[16:19], s60 offen sc1
  s_waitcnt vmcnt(0)
  v_cmp_ne_u32 vcc, s45, v34
  s_cbranch_vccnz lr_3
ld_4:
  s_mov_b64 exec, -1
  s_add_u32 s57, s57, s46
  s_mul_i32 s34, s53, 12288
  s_add_u32 s57, s57, s34
  buffer_load_dwordx4 v[128:131], v10, s[16:19], s57 offen offset:0 sc1
  buffer_load_dwordx4 v[132:135], v10, s[16:19], s57 offen offset:2048 sc1
  s_add_u32 s57, s57, 4096
  buffer_load_dwordx4 v[136:139], v10, s[16:19], s57 offen offset:0 sc1
  buffer_load_dwordx4 v[140:143], v10, s[16:19], s57 offen offset:2048 sc1
  s_add_u32 s57, s57, 4096
  buffer_load_dwordx4 v[144:147], v10, s[16:19], s57 offen offset:0 sc1
  buffer_load_dwordx4 v[148:151], v10, s[16:19], s57 offen offset:2048 sc1
  s_add_u32 s34, s47, 147456
  v_add_u32 v4, s34, v10
  v_xor_b32 v5, 1024, v4
  s_waitcnt vmcnt(4)
  v_pk_add_f32 v[128:129], v[128:129], v[132:133]
  v_pk_add_f32 v[130:131], v[130:131], v[134:135]
  s_waitcnt vmcnt(3)
  v_pk_add_f32 v[128:129], v[128:129], v[136:137]
  v_pk_add_f32 v[130:131], v[130:131], v[138:139]
  s_waitcnt vmcnt(2)
  v_pk_add_f32 v[128:129], v[128:129], v[140:141]
  v_pk_add_f32 v[130:131], v[130:131], v[142:143]
  s_waitcnt vmcnt(1)
  v_pk_add_f32 v[128:129], v[128:129], v[144:145]
  v_pk_add_f32 v[130:131], v[130:131], v[146:147]
  s_waitcnt vmcnt(0)
  v_pk_add_f32 v[128:129], v[128:129], v[148:149]
  v_pk_add_f32 v[130:131], v[130:131], v[150:151]
  ds_write_b128 v4, v[128:131]
  s_waitcnt lgkmcnt(0)
  s_barrier
  ds_read_b128 v[132:135], v5
  ds_read_b128 v[32:35], v24 offset:0
  ds_read_b128 v[36:39], v24 offset:2048
  ds_read_b128 v[40:43], v24 offset:4096
  ds_read_b128 v[44:47], v24 offset:6144
  ds_read_b128 v[48:51], v24 offset:8192
  s_waitcnt lgkmcnt(4)
  v_mfma_f32_32x32x16_bf16 v[64:79], v[160:163], v[32:35], 0
  ds_read_b128 v[52:55], v24 offset:10240
  s_waitcnt lgkmcnt(4)
  v_mfma_f32_32x32x16_bf16 v[64:79], v[164:167], v[36:39], v[64:79]
  ds_read_b128 v[32:35], v24 offset:12288
  v_add_f32 v128, v128, v132
  v_add_f32 v129, v129, v133
  v_add_f32 v130, v130, v134
  v_add_f32 v131, v131, v135
  v_mul_f32 v128, v128, v56
  v_mul_f32 v129, v129, v57
  s_waitcnt lgkmcnt(4)
  v_mfma_f32_32x32x16_bf16 v[64:79], v[168:171], v[40:43], v[64:79]
  ds_read_b128 v[36:39], v24 offset:14336
  v_mul_f32 v130, v130, v58
  v_mul_f32 v131, v131, v59
  v_max_f32 v132, v128, v129
  v_max3_f32 v132, v132, v130, v131
  v_mov_b32 v133, v132
  s_mov_b32 s64, 0x11111111
  s_waitcnt lgkmcnt(4)
  v_mfma_f32_32x32x16_bf16 v[64:79], v[172:175], v[44:47], v[64:79]
  s_mov_b32 s65, 0x11111111
  v_permlane32_swap_b32 v132, v133
  v_max_f32 v132, v132, v133
  v_mul_f32 v132, v60, v132
  v_fma_f32 v128, v128, v60, -v132
  v_fma_f32 v129, v129, v60, -v132
  s_waitcnt lgkmcnt(3)
  v_mfma_f32_32x32x16_bf16 v[64:79], v[176:179], v[48:51], v[64:79]
  v_fma_f32 v130, v130, v60, -v132
  v_fma_f32 v131, v131, v60, -v132
  v_exp_f32 v128, v128
  v_exp_f32 v129, v129
  v_exp_f32 v130, v130
  v_exp_f32 v131, v131
  s_waitcnt lgkmcnt(2)
  v_mfma_f32_32x32x16_bf16 v[64:79], v[180:183], v[52:55], v[64:79]
  v_add_f32 v132, v128, v129
  v_add_f32 v133, v130, v131
  v_add_f32 v132, v132, v133
  v_mov_b32 v133, v132
  v_mul_f32 v128, v128, v56
  v_mul_f32 v129, v129, v57
  s_barrier
  ds_read_b128 v[40:43], v24 offset:16384
  ds_read_b128 v[44:47], v24 offset:18432
  ds_read_b128 v[48:51], v24 offset:20480
  s_waitcnt lgkmcnt(4)
  v_mfma_f32_32x32x16_bf16 v[64:79], v[184:187], v[32:35], v[64:79]
  ds_read_b128 v[52:55], v24 offset:22528
  v_permlane32_swap_b32 v132, v133
  v_add_f32 v132, v132, v133
  v_rcp_f32 v132, v132
  v_mul_f32 v130, v130, v58
  v_mul_f32 v131, v131, v59
  v_mul_f32 v128, v128, v132
  s_waitcnt lgkmcnt(4)
  v_mfma_f32_32x32x16_bf16 v[64:79], v[188:191], v[36:39], v[64:79]
  ds_read_b128 v[32:35], v24 offset:24576
  v_mul_f32 v129, v129, v132
  v_mul_f32 v130, v130, v132
  v_mul_f32 v131, v131, v132
  v_cvt_pk_bf16_f32 v132, v128, v129
  v_cvt_pk_bf16_f32 v133, v130, v131
  v_cndmask_b32 v136, 0, v132, s[64:65]
  s_waitcnt lgkmcnt(4)
  v_mfma_f32_32x32x16_bf16 v[64:79], v[192:195], v[40:43], v[64:79]
  ds_read_b128 v[36:39], v24 offset:26624
  v_cndmask_b32 v137, 0, v133, s[64:65]
  s_lshl_b64 s[64:65], s[64:65], 1
  v_cndmask_b32 v138, 0, v132, s[64:65]
  v_cndmask_b32 v139, 0, v133, s[64:65]
  s_lshl_b64 s[64:65], s[64:65], 1
  v_cndmask_b32 v140, 0, v132, s[64:65]
  s_waitcnt lgkmcnt(4)
  v_mfma_f32_32x32x16_bf16 v[64:79], v[196:199], v[44:47], v[64:79]
  ds_read_b128 v[40:43], v24 offset:28672
  v_cndmask_b32 v141, 0, v133, s[64:65]
  s_lshl_b64 s[64:65], s[64:65], 1
  v_cndmask_b32 v142, 0, v132, s[64:65]
  v_cndmask_b32 v143, 0, v133, s[64:65]
  v_mov_b32 v104, 0
  v_mov_b32 v105, 0
  s_waitcnt lgkmcnt(4)
  v_mfma_f32_32x32x16_bf16 v[64:79], v[200:203], v[48:51], v[64:79]
  ds_read_b128 v[44:47], v24 offset:30720
  s_mov_b32 s36, 0x3f803f80
  s_waitcnt lgkmcnt(4)
  v_mfma_f32_32x32x16_bf16 v[64:79], v[204:207], v[52:55], v[64:79]
  ds_read_b128 v[48:51], v24 offset:32768
  s_waitcnt lgkmcnt(4)
  v_mfma_f32_32x32x16_bf16 v[64:79], v[208:211], v[32:35], v[64:79]
  ds_read_b128 v[52:55], v24 offset:34816
  s_waitcnt lgkmcnt(4)
  v_mfma_f32_32x32x16_bf16 v[64:79], v[212:215], v[36:39], v[64:79]
  s_waitcnt lgkmcnt(3)
  v_mfma_f32_32x32x16_bf16 v[64:79], v[216:219], v[40:43], v[64:79]
  s_waitcnt lgkmcnt(2)
  v_mfma_f32_32x32x16_bf16 v[64:79], v[220:223], v[44:47], v[64:79]
  s_barrier
  ds_read_b128 v[32:35], v24 offset:36864
  ds_read_b128 v[36:39], v24 offset:38912
  ds_read_b128 v[40:43], v24 offset:40960
  s_waitcnt lgkmcnt(4)
  v_mfma_f32_32x32x16_bf16 v[64:79], v[224:227], v[48:51], v[64:79]
  ds_read_b128 v[44:47], v24 offset:43008
  s_waitcnt lgkmcnt(4)
  v_mfma_f32_32x32x16_bf16 v[64:79], v[228:231], v[52:55], v[64:79]
  ds_read_b128 v[48:51], v24 offset:45056
  s_waitcnt lgkmcnt(4)
  v_mfma_f32_32x32x16_bf16 v[64:79], v[232:235], v[32:35], v[64:79]
  ds_read_b128 v[52:55], v24 offset:47104
  s_waitcnt lgkmcnt(4)
  v_mfma_f32_32x32x16_bf16 v[64:79], v[236:239], v[36:39], v[64:79]
  ds_read2st64_b32 v[32:33], v25 offset0:0 offset1:1
  ds_read2st64_b32 v[34:35], v25 offset0:2 offset1:3
  s_waitcnt lgkmcnt(5)
  v_mfma_f32_32x32x16_bf16 v[64:79], v[240:243], v[40:43], v[64:79]
  ds_read2st64_b32 v[36:37], v26 offset0:0 offset1:1
  ds_read2st64_b32 v[38:39], v26 offset0:2 offset1:3
  s_waitcnt lgkmcnt(6)
  v_mfma_f32_32x32x16_bf16 v[64:79], v[244:247], v[44:47], v[64:79]
  s_waitcnt lgkmcnt(5)
  v_mfma_f32_32x32x16_bf16 v[64:79], v[248:251], v[48:51], v[64:79]
  s_waitcnt lgkmcnt(4)
  v_mfma_f32_32x32x16_bf16 v[64:79], v[252:255], v[52:55], v[64:79]
  s_waitcnt lgkmcnt(2)
  v_mfma_f32_32x32x16_bf16 v[64:79], v[124:127], v[32:35], v[64:79]
  s_waitcnt lgkmcnt(0)
  v_mfma_f32_32x32x16_bf16 v[64:79], v[120:123], v[36:39], v[64:79]
  s_nop 11
  v_cvt_pk_bf16_f32 v144, v64, v65
  v_cvt_pk_bf16_f32 v145, v66, v67
  v_cvt_pk_bf16_f32 v146, v68, v69
  v_cvt_pk_bf16_f32 v147, v70, v71
  v_cvt_pk_bf16_f32 v148, v72, v73
  v_cvt_pk_bf16_f32 v149, v74, v75
  v_cvt_pk_bf16_f32 v150, v76, v77
  v_cvt_pk_bf16_f32 v151, v78, v79
  v_mfma_f32_32x32x16_bf16 v[80:95], v[144:147], v[136:139], v[80:95]
  s_nop 0
  v_mfma_f32_32x32x16_bf16 v[80:95], v[148:151], v[140:143], v[80:95]
  s_nop 11
  v_cvt_pk_bf16_f32 v152, v80, v81
  v_cvt_pk_bf16_f32 v153, v82, v83
  v_cvt_pk_bf16_f32 v154, v84, v85
  v_cvt_pk_bf16_f32 v155, v86, v87
  v_cvt_pk_bf16_f32 v156, v88, v89
  v_cvt_pk_bf16_f32 v157, v90, v91
  v_cvt_pk_bf16_f32 v158, v92, v93
  v_cvt_pk_bf16_f32 v159, v94, v95
  buffer_store_dwordx4 v[152:155], v19, s[16:19], s58 offen sc1
  buffer_store_dwordx4 v[156:159], v19, s[16:19], s58 offen offset:512 sc1
  v_dot2c_f32_bf16 v104, s36, v152
  v_dot2c_f32_bf16 v105, v152, v152
  v_dot2c_f32_bf16 v104, s36, v153
  v_dot2c_f32_bf16 v105, v153, v153
  v_dot2c_f32_bf16 v104, s36, v154
  v_dot2c_f32_bf16 v105, v154, v154
  v_dot2c_f32_bf16 v104, s36, v155
  v_dot2c_f32_bf16 v105, v155, v155
  v_dot2c_f32_bf16 v104, s36, v156
  v_dot2c_f32_bf16 v105, v156, v156
  v_dot2c_f32_bf16 v104, s36, v157
  v_dot2c_f32_bf16 v105, v157, v157
  v_dot2c_f32_bf16 v104, s36, v158
  v_dot2c_f32_bf16 v105, v158, v158
  v_dot2c_f32_bf16 v104, s36, v159
  v_dot2c_f32_bf16 v105, v159, v159
  s_nop 1
  v_mov_b32 v106, v104
  v_mov_b32 v107, v105
  s_nop 0
  v_permlane32_swap_b32 v104, v106
  v_permlane32_swap_b32 v105, v107
  v_add_f32 v104, v104, v106
  v_add_f32 v105, v105, v107
  s_mov_b32 exec_hi, 0
  buffer_store_dwordx4 v[104:107], v20, s[16:19], s59 offen sc1
  s_mov_b32 exec_hi, -1
  s_mov_b32 s34, 8044544
  s_waitcnt vmcnt(0) lgkmcnt(0)
  s_barrier
  s_cmp_lg_u32 s41, 0
  s_cbranch_scc1 f0_6
  s_mov_b64 exec, 15
  v_lshl_add_u32 v32, v1, 4, s63
  v_mov_b32 v34, s44
  v_mov_b32 v35, s44
  v_mov_b32 v36, s44
  v_mov_b32 v37, s44
  buffer_store_dwordx4 v[34:37], v32, s[16:19], s34 offen sc0 sc1
  s_mov_b64 exec, -1
f0_6:
  s_branch P2_c
K_pre:
  s_mov_b32 s50, s42
  s_and_b32 s59, s40, 1
  s_lshr_b32 s60, s40, 1
  s_cmp_ge_u32 s50, 3
  s_cbranch_scc1 W_id0
  s_mov_b32 s55, 2
  s_mov_b32 s51, s60
  s_mul_i32 s52, s59, 3
  s_add_u32 s52, s52, s50
  s_cmp_eq_u32 s43, 0
  s_cbranch_scc1 W_id2
  v_lshrrev_b32 v4, 1, v2
  v_xor_b32 v4, v4, v3
  v_mul_u32_u24 v5, 2304, v2
  v_lshl_add_u32 v12, v4, 4, v5
  v_xor_b32 v13, 64, v12
  v_lshlrev_b32 v4, 1, v2
  v_and_b32 v4, 4, v4
  v_xor_b32 v4, v4, v3
  v_mul_u32_u24 v5, 768, v2
  v_lshl_add_u32 v14, v4, 4, v5
  s_lshl_b32 s34, s51, 2
  s_add_u32 s34, s34, s41
  s_mul_i32 s53, s34, 55296
  s_add_u32 s53, s53, 1536
  s_mul_i32 s57, s41, 18432
  s_mul_i32 s54, s41, 12288
  s_lshl_b32 s34, s52, 7
  s_add_u32 s54, s54, s34
  s_lshl_b32 s58, s41, 11
  s_and_b32 s34, s41, 1
  s_lshl_b32 s34, s34, 6
  v_xor_b32 v12, s34, v12
  v_xor_b32 v13, s34, v13
  s_mul_i32 s34, s51, 3
  s_lshr_b32 s34, s34, 1
  s_add_u32 s34, s34, s52
  s_mov_b32 s48, s34
  s_cmp_ge_u32 s48, 6
  s_cselect_b32 s35, 6, 0
  s_sub_u32 s48, s48, s35
  s_lshl_b32 s35, s48, 7
  s_add_u32 s59, s53, s35
  s_mul_i32 s35, s48, 49152
  s_add_u32 s65, s54, s35
  s_add_u32 s48, s48, 1
  s_mov_b32 s10, 884736
  s_mov_b32 s11, 0x20000
  s_mov_b32 s14, 294912
  s_mov_b32 s15, 0x20000
  s_waitcnt lgkmcnt(0)
  s_mov_b32 s8, s22
  s_mov_b32 s9, s23
  s_mov_b32 s12, s28
  s_mov_b32 s13, s29
  s_add_u32 s56, s59, 0
  s_add_u32 m0, s57, 0
  s_nop 0
  buffer_load_dwordx4 v12, s[8:11], s56 offen lds
  s_add_u32 s56, s59, 18432
  s_add_u32 m0, s57, 6144
  s_nop 0
  buffer_load_dwordx4 v13, s[8:11], s56 offen lds
  s_add_u32 s56, s59, 36864
  s_add_u32 m0, s57, 12288
  s_nop 0
  buffer_load_dwordx4 v12, s[8:11], s56 offen lds
  s_add_u32 s56, s65, 0
  s_add_u32 m0, s58, 98304
  s_nop 0
  buffer_load_dwordx4 v14, s[12:15], s56 offen lds
  s_add_u32 s56, s65, 6144
  s_add_u32 m0, s58, 99328
  s_nop 0
  buffer_load_dwordx4 v14, s[12:15], s56 offen lds
  s_cmp_ge_u32 s48, 6
  s_cselect_b32 s35, 6, 0
  s_sub_u32 s48, s48, s35
  s_lshl_b32 s35, s48, 7
  s_add_u32 s60, s53, s35
  s_mul_i32 s35, s48, 49152
  s_add_u32 s66, s54, s35
  s_add_u32 s48, s48, 1
  s_add_u32 s56, s60, 0
  s_add_u32 m0, s57, 1024
  s_nop 0
  buffer_load_dwordx4 v12, s[8:11], s56 offen lds
  s_add_u32 s56, s60, 18432
  s_add_u32 m0, s57, 7168
  s_nop 0
  buffer_load_dwordx4 v13, s[8:11], s56 offen lds
  s_add_u32 s56, s60, 36864
  s_add_u32 m0, s57, 13312
  s_nop 0
  buffer_load_dwordx4 v12, s[8:11], s56 offen lds
  s_add_u32 s56, s66, 0
  s_add_u32 m0, s58, 106496
  s_nop 0
  buffer_load_dwordx4 v14, s[12:15], s56 offen lds
  s_add_u32 s56, s66, 6144
  s_add_u32 m0, s58, 107520
  s_nop 0
  buffer_load_dwordx4 v14, s[12:15], s56 offen lds
  s_cmp_ge_u32 s48, 6
  s_cselect_b32 s35, 6, 0
  s_sub_u32 s48, s48, s35
  s_lshl_b32 s35, s48, 7
  s_add_u32 s61, s53, s35
  s_mul_i32 s35, s48, 49152
  s_add_u32 s67, s54, s35
  s_add_u32 s48, s48, 1
  s_add_u32 s56, s61, 0
  s_add_u32 m0, s57, 2048
  s_nop 0
  buffer_load_dwordx4 v12, s[8:11], s56 offen lds
  s_add_u32 s56, s61, 18432
  s_add_u32 m0, s57, 8192
  s_nop 0
  buffer_load_dwordx4 v13, s[8:11], s56 offen lds
  s_add_u32 s56, s61, 36864
  s_add_u32 m0, s57, 14336
  s_nop 0
  buffer_load_dwordx4 v12, s[8:11], s56 offen lds
  s_add_u32 s56, s67, 0
  s_add_u32 m0, s58, 114688
  s_nop 0
  buffer_load_dwordx4 v14, s[12:15], s56 offen lds
  s_add_u32 s56, s67, 6144
  s_add_u32 m0, s58, 115712
  s_nop 0
  buffer_load_dwordx4 v14, s[12:15], s56 offen lds
  s_cmp_ge_u32 s48, 6
  s_cselect_b32 s35, 6, 0
  s_sub_u32 s48, s48, s35
  s_lshl_b32 s35, s48, 7
  s_add_u32 s62, s53, s35
  s_mul_i32 s35, s48, 49152
  s_add_u32 s68, s54, s35
  s_add_u32 s48, s48, 1
  s_cmp_ge_u32 s48, 6
  s_cselect_b32 s35, 6, 0
  s_sub_u32 s48, s48, s35
  s_lshl_b32 s35, s48, 7
  s_add_u32 s63, s53, s35
  s_mul_i32 s35, s48, 49152
  s_add_u32 s69, s54, s35
  s_add_u32 s48, s48, 1
  s_cmp_ge_u32 s48, 6
  s_cselect_b32 s35, 6, 0
  s_sub_u32 s48, s48, s35
  s_lshl_b32 s35, s48, 7
  s_add_u32 s64, s53, s35
  s_mul_i32 s35, s48, 49152
  s_add_u32 s3, s54, s35
  s_add_u32 s48, s48, 1
  s_mov_b32 s34, 8077312
  s_load_dword s44, s[32:33], s34
  s_mov_b32 s16, s32
  s_mov_b32 s17, s33
  s_mov_b32 s18, 16777216
  s_mov_b32 s19, 0x20000
  s_mov_b32 s24, s38
  s_mov_b32 s25, s39
  s_mov_b32 s26, 1572864
  s_mov_b32 s27, 0x20000
  s_lshl_b32 s47, s41, 10
  s_getreg_b32 s45, hwreg(HW_REG_XCC_ID)
  s_and_b32 s45, s45, 15
  s_add_u32 s45, s45, 1
  s_waitcnt vmcnt(10)
  s_barrier
  s_add_u32 s56, s62, 0
  s_add_u32 m0, s57, 3072
  s_nop 0
  buffer_load_dwordx4 v12, s[8:11], s56 offen lds
  s_add_u32 s56, s62, 18432
  s_add_u32 m0, s57, 9216
  s_nop 0
  buffer_load_dwordx4 v13, s[8:11], s56 offen lds
  s_add_u32 s56, s62, 36864
  s_add_u32 m0, s57, 15360
  s_nop 0
  buffer_load_dwordx4 v12, s[8:11], s56 offen lds
  s_add_u32 s56, s68, 0
  s_add_u32 m0, s58, 122880
  s_nop 0
  buffer_load_dwordx4 v14, s[12:15], s56 offen lds
  s_add_u32 s56, s68, 6144
  s_add_u32 m0, s58, 123904
  s_nop 0
  buffer_load_dwordx4 v14, s[12:15], s56 offen lds
  s_waitcnt vmcnt(10)
  s_barrier
  s_add_u32 s56, s63, 0
  s_add_u32 m0, s57, 4096
  s_nop 0
  buffer_load_dwordx4 v12, s[8:11], s56 offen lds
  s_add_u32 s56, s63, 18432
  s_add_u32 m0, s57, 10240
  s_nop 0
  buffer_load_dwordx4 v13, s[8:11], s56 offen lds
  s_add_u32 s56, s63, 36864
  s_add_u32 m0, s57, 16384
  s_nop 0
  buffer_load_dwordx4 v12, s[8:11], s56 offen lds
  s_add_u32 s56, s69, 0
  s_add_u32 m0, s58, 131072
  s_nop 0
  buffer_load_dwordx4 v14, s[12:15], s56 offen lds
  s_add_u32 s56, s69, 6144
  s_add_u32 m0, s58, 132096
  s_nop 0
  buffer_load_dwordx4 v14, s[12:15], s56 offen lds
  s_waitcnt vmcnt(10)
  s_barrier
  s_add_u32 s56, s64, 0
  s_add_u32 m0, s57, 5120
  s_nop 0
  buffer_load_dwordx4 v12, s[8:11], s56 offen lds
  s_add_u32 s56, s64, 18432
  s_add_u32 m0, s57, 11264
  s_nop 0
  buffer_load_dwordx4 v13, s[8:11], s56 offen lds
  s_add_u32 s56, s64, 36864
  s_add_u32 m0, s57, 17408
  s_nop 0
  buffer_load_dwordx4 v12, s[8:11], s56 offen lds
  s_add_u32 s56, s3, 0
  s_add_u32 m0, s58, 139264
  s_nop 0
  buffer_load_dwordx4 v14, s[12:15], s56 offen lds
  s_add_u32 s56, s3, 6144
  s_add_u32 m0, s58, 140288
  s_nop 0
  buffer_load_dwordx4 v14, s[12:15], s56 offen lds
  s_waitcnt vmcnt(10)
  s_barrier
  s_waitcnt vmcnt(5)
  s_barrier
  s_waitcnt vmcnt(0)
  s_barrier
  s_branch W_done
W_id2:
  s_mul_i32 s49, s40, 3
  s_add_u32 s49, s49, s50
  s_add_u32 s49, s49, 36
  s_branch W_id1
W_id0:
  s_mul_i32 s35, s60, 9
  s_mul_i32 s61, s59, 5
  s_add_u32 s35, s35, s61
  s_add_u32 s35, s35, s50
  s_sub_u32 s35, s35, 3
  s_mul_i32 s61, s35, 43
  s_lshr_b32 s61, s61, 8
  s_mul_i32 s62, s61, 6
  s_sub_u32 s52, s35, s62
  s_cmp_ge_u32 s61, 3
  s_cselect_b32 s55, 1, 0
  s_mul_i32 s62, s55, 3
  s_sub_u32 s51, s61, s62
  s_add_u32 s62, s50, s59
  s_add_u32 s49, s60, 60
  s_cmp_ge_u32 s62, 8
  s_cselect_b32 s55, 3, s55
  s_cselect_b32 s49, s49, s35
W_id1:
  s_mov_b32 s58, s49
  s_lshl_b32 s47, s41, 10
  s_getreg_b32 s45, hwreg(HW_REG_XCC_ID)
  s_and_b32 s45, s45, 15
  s_add_u32 s45, s45, 1
  s_getpc_b64 s[48:49]
pc_11:
  s_sub_u32 s48, s48, pc_11-standalone__video_timesformer__vision_kernel
  s_subb_u32 s49, s49, 0
  s_lshl_b32 s34, s42, 2
  s_add_u32 s34, s34, s41
  s_and_b32 s34, s34, 31
  s_lshl_b32 s34, s34, 10
  v_lshl_add_u32 v9, v1, 4, s34
  global_load_dwordx4 v[252:255], v9, s[48:49]
  s_mov_b32 s49, s58
  s_mov_b32 s34, 8077312
  s_waitcnt lgkmcnt(0)
  s_load_dword s44, s[32:33], s34
  s_mov_b32 s16, s32
  s_mov_b32 s17, s33
  s_mov_b32 s18, 16777216
  s_mov_b32 s19, 0x20000
  s_mov_b32 s24, s38
  s_mov_b32 s25, s39
  s_mov_b32 s26, 1572864
  s_mov_b32 s27, 0x20000
  s_cmp_eq_u32 s55, 3
  s_cbranch_scc1 W_done
  s_cmp_lg_u32 s43, 0
  s_cbranch_scc1 W_ld
  v_and_b32 v2, 31, v1
  v_lshrrev_b32 v3, 5, v1
  v_and_b32 v4, 19, v2
  v_bfe_u32 v5, v2, 2, 1
  v_lshl_add_u32 v4, v5, 3, v4
  v_bfe_u32 v5, v2, 3, 1
  v_lshl_add_u32 v4, v5, 2, v4
  v_lshrrev_b32 v5, 3, v4
  v_mul_u32_u24 v5, 6144, v5
  v_and_b32 v6, 7, v4
  v_lshl_add_u32 v5, v6, 7, v5
  v_bfe_u32 v6, v4, 1, 3
  v_xor_b32 v6, v6, v3
  v_lshl_add_u32 v11, v6, 4, v5
  v_bfe_u32 v6, v1, 2, 2
  v_lshl_add_u32 v4, v3, 3, v6
  v_lshlrev_b32 v4, 7, v4
  v_lshrrev_b32 v7, 1, v6
  v_lshl_add_u32 v4, v7, 6, v4
  v_bfe_u32 v7, v1, 4, 1
  v_lshl_add_u32 v12, v7, 5, v4
  s_mov_b32 s37, 0x3f803f80
  s_mul_i32 s34, s41, 24576
  v_add_u32 v14, s34, v11
  v_xor_b32 v15, 32, v14
  v_xor_b32 v16, 64, v14
  v_xor_b32 v17, 96, v14
  s_cmp_lg_u32 s55, 2
  s_cbranch_scc1 W_c0
  s_min_u32 s59, s41, 2
  s_mul_i32 s34, s59, 24576
  v_add_u32 v14, s34, v11
  v_xor_b32 v15, 32, v14
  v_xor_b32 v16, 64, v14
  v_xor_b32 v17, 96, v14
  v_and_b32 v7, 1, v1
  v_lshl_add_u32 v4, v7, 4, v12
  v_bfe_u32 v7, v1, 1, 1
  v_lshl_add_u32 v4, v7, 3, v4
  v_add_u32 v18, 98304, v4
  v_xor_b32 v19, 64, v18
  s_mul_i32 s34, s51, 3
  s_add_u32 s34, s34, s59
  s_mul_i32 s35, s52, 53248
  s_add_u32 s35, s35, 0
  s_lshl_b32 s36, s34, 12
  s_add_u32 s61, s35, s36
  s_lshl_b32 s36, s34, 8
  s_add_u32 s35, s35, s36
  s_add_u32 s62, s35, 49152
  v_lshlrev_b32 v30, 2, v1
  s_mul_i32 s63, s51, 6
  s_add_u32 s63, s63, s52
  s_lshl_b32 s63, s63, 7
  s_mov_b32 s64, 8028160
  s_cmp_eq_u32 s41, 3
  s_cbranch_scc1 W_c5
  s_barrier
  ds_read_b128 v[32:35], v14 offset:0
  ds_read_b64_tr_b16 v[48:49], v18 offset:0
  ds_read_b64_tr_b16 v[50:51], v18 offset:512
  ds_read_b64_tr_b16 v[52:53], v19 offset:0
  ds_read_b64_tr_b16 v[54:55], v19 offset:512
  ds_read_b128 v[36:39], v15 offset:0
  ds_read_b64_tr_b16 v[56:57], v18 offset:2048
  ds_read_b64_tr_b16 v[58:59], v18 offset:2560
  ds_read_b64_tr_b16 v[60:61], v19 offset:2048
  ds_read_b64_tr_b16 v[62:63], v19 offset:2560
  ds_read_b128 v[40:43], v16 offset:0
  ds_read_b64_tr_b16 v[64:65], v18 offset:4096
  ds_read_b64_tr_b16 v[66:67], v18 offset:4608
  ds_read_b64_tr_b16 v[68:69], v19 offset:4096
  ds_read_b64_tr_b16 v[70:71], v19 offset:4608
  ds_read_b128 v[44:47], v17 offset:0
  ds_read_b64_tr_b16 v[72:73], v18 offset:6144
  ds_read_b64_tr_b16 v[74:75], v18 offset:6656
  ds_read_b64_tr_b16 v[76:77], v19 offset:6144
  ds_read_b64_tr_b16 v[78:79], v19 offset:6656
  s_waitcnt lgkmcnt(15)
  v_mfma_f32_32x32x16_bf16 v[128:143], v[32:35], v[48:51], 0
  v_mfma_f32_32x32x16_bf16 v[144:159], v[32:35], v[52:55], 0
  s_waitcnt lgkmcnt(10)
  v_mfma_f32_32x32x16_bf16 v[128:143], v[36:39], v[56:59], v[128:143]
  v_mfma_f32_32x32x16_bf16 v[144:159], v[36:39], v[60:63], v[144:159]
  s_waitcnt lgkmcnt(0)
  s_barrier
  ds_read_b128 v[80:83], v14 offset:1024
  ds_read_b64_tr_b16 v[96:97], v18 offset:8192
  ds_read_b64_tr_b16 v[98:99], v18 offset:8704
  ds_read_b64_tr_b16 v[100:101], v19 offset:8192
  ds_read_b64_tr_b16 v[102:103], v19 offset:8704
  v_mfma_f32_32x32x16_bf16 v[128:143], v[40:43], v[64:67], v[128:143]
  v_mfma_f32_32x32x16_bf16 v[144:159], v[40:43], v[68:71], v[144:159]
  ds_read_b128 v[84:87], v15 offset:1024
  ds_read_b64_tr_b16 v[104:105], v18 offset:10240
  ds_read_b64_tr_b16 v[106:107], v18 offset:10752
  ds_read_b64_tr_b16 v[108:109], v19 offset:10240
  ds_read_b64_tr_b16 v[110:111], v19 offset:10752
  v_mfma_f32_32x32x16_bf16 v[128:143], v[44:47], v[72:75], v[128:143]
  v_mfma_f32_32x32x16_bf16 v[144:159], v[44:47], v[76:79], v[144:159]
  ds_read_b128 v[88:91], v16 offset:1024
  ds_read_b64_tr_b16 v[112:113], v18 offset:12288
  ds_read_b64_tr_b16 v[114:115], v18 offset:12800
  ds_read_b64_tr_b16 v[116:117], v19 offset:12288
  ds_read_b64_tr_b16 v[118:119], v19 offset:12800
  ds_read_b128 v[92:95], v17 offset:1024
  ds_read_b64_tr_b16 v[120:121], v18 offset:14336
  ds_read_b64_tr_b16 v[122:123], v18 offset:14848
  ds_read_b64_tr_b16 v[124:125], v19 offset:14336
  ds_read_b64_tr_b16 v[126:127], v19 offset:14848
  s_waitcnt lgkmcnt(15)
  v_mfma_f32_32x32x16_bf16 v[128:143], v[80:83], v[96:99], v[128:143]
  v_mfma_f32_32x32x16_bf16 v[144:159], v[80:83], v[100:103], v[144:159]
  s_waitcnt lgkmcnt(10)
  v_mfma_f32_32x32x16_bf16 v[128:143], v[84:87], v[104:107], v[128:143]
  v_mfma_f32_32x32x16_bf16 v[144:159], v[84:87], v[108:111], v[144:159]
  s_waitcnt lgkmcnt(0)
  s_barrier
  ds_read_b128 v[32:35], v14 offset:2048
  ds_read_b64_tr_b16 v[48:49], v18 offset:16384
  ds_read_b64_tr_b16 v[50:51], v18 offset:16896
  ds_read_b64_tr_b16 v[52:53], v19 offset:16384
  ds_read_b64_tr_b16 v[54:55], v19 offset:16896
  v_mfma_f32_32x32x16_bf16 v[128:143], v[88:91], v[112:115], v[128:143]
  v_mfma_f32_32x32x16_bf16 v[144:159], v[88:91], v[116:119], v[144:159]
  ds_read_b128 v[36:39], v15 offset:2048
  ds_read_b64_tr_b16 v[56:57], v18 offset:18432
  ds_read_b64_tr_b16 v[58:59], v18 offset:18944
  ds_read_b64_tr_b16 v[60:61], v19 offset:18432
  ds_read_b64_tr_b16 v[62:63], v19 offset:18944
  v_mfma_f32_32x32x16_bf16 v[128:143], v[92:95], v[120:123], v[128:143]
  v_mfma_f32_32x32x16_bf16 v[144:159], v[92:95], v[124:127], v[144:159]
  ds_read_b128 v[40:43], v16 offset:2048
  ds_read_b64_tr_b16 v[64:65], v18 offset:20480
  ds_read_b64_tr_b16 v[66:67], v18 offset:20992
  ds_read_b64_tr_b16 v[68:69], v19 offset:20480
  ds_read_b64_tr_b16 v[70:71], v19 offset:20992
  ds_read_b128 v[44:47], v17 offset:2048
  ds_read_b64_tr_b16 v[72:73], v18 offset:22528
  ds_read_b64_tr_b16 v[74:75], v18 offset:23040
  ds_read_b64_tr_b16 v[76:77], v19 offset:22528
  ds_read_b64_tr_b16 v[78:79], v19 offset:23040
  s_waitcnt lgkmcnt(15)
  v_mfma_f32_32x32x16_bf16 v[128:143], v[32:35], v[48:51], v[128:143]
  v_mfma_f32_32x32x16_bf16 v[144:159], v[32:35], v[52:55], v[144:159]
  s_waitcnt lgkmcnt(10)
  v_mfma_f32_32x32x16_bf16 v[128:143], v[36:39], v[56:59], v[128:143]
  v_mfma_f32_32x32x16_bf16 v[144:159], v[36:39], v[60:63], v[144:159]
  s_waitcnt lgkmcnt(0)
  s_barrier
  ds_read_b128 v[80:83], v14 offset:3072
  ds_read_b64_tr_b16 v[96:97], v18 offset:24576
  ds_read_b64_tr_b16 v[98:99], v18 offset:25088
  ds_read_b64_tr_b16 v[100:101], v19 offset:24576
  ds_read_b64_tr_b16 v[102:103], v19 offset:25088
  v_mfma_f32_32x32x16_bf16 v[128:143], v[40:43], v[64:67], v[128:143]
  v_mfma_f32_32x32x16_bf16 v[144:159], v[40:43], v[68:71], v[144:159]
  ds_read_b128 v[84:87], v15 offset:3072
  ds_read_b64_tr_b16 v[104:105], v18 offset:26624
  ds_read_b64_tr_b16 v[106:107], v18 offset:27136
  ds_read_b64_tr_b16 v[108:109], v19 offset:26624
  ds_read_b64_tr_b16 v[110:111], v19 offset:27136
  v_mfma_f32_32x32x16_bf16 v[128:143], v[44:47], v[72:75], v[128:143]
  v_mfma_f32_32x32x16_bf16 v[144:159], v[44:47], v[76:79], v[144:159]
  ds_read_b128 v[88:91], v16 offset:3072
  ds_read_b64_tr_b16 v[112:113], v18 offset:28672
  ds_read_b64_tr_b16 v[114:115], v18 offset:29184
  ds_read_b64_tr_b16 v[116:117], v19 offset:28672
  ds_read_b64_tr_b16 v[118:119], v19 offset:29184
  ds_read_b128 v[92:95], v17 offset:3072
  ds_read_b64_tr_b16 v[120:121], v18 offset:30720
  ds_read_b64_tr_b16 v[122:123], v18 offset:31232
  ds_read_b64_tr_b16 v[124:125], v19 offset:30720
  ds_read_b64_tr_b16 v[126:127], v19 offset:31232
  s_waitcnt lgkmcnt(15)
  v_mfma_f32_32x32x16_bf16 v[128:143], v[80:83], v[96:99], v[128:143]
  v_mfma_f32_32x32x16_bf16 v[144:159], v[80:83], v[100:103], v[144:159]
  s_waitcnt lgkmcnt(10)
  v_mfma_f32_32x32x16_bf16 v[128:143], v[84:87], v[104:107], v[128:143]
  v_mfma_f32_32x32x16_bf16 v[144:159], v[84:87], v[108:111], v[144:159]
  s_waitcnt lgkmcnt(0)
  s_barrier
  ds_read_b128 v[32:35], v14 offset:4096
  ds_read_b64_tr_b16 v[48:49], v18 offset:32768
  ds_read_b64_tr_b16 v[50:51], v18 offset:33280
  ds_read_b64_tr_b16 v[52:53], v19 offset:32768
  ds_read_b64_tr_b16 v[54:55], v19 offset:33280
  v_mfma_f32_32x32x16_bf16 v[128:143], v[88:91], v[112:115], v[128:143]
  v_mfma_f32_32x32x16_bf16 v[144:159], v[88:91], v[116:119], v[144:159]
  ds_read_b128 v[36:39], v15 offset:4096
  ds_read_b64_tr_b16 v[56:57], v18 offset:34816
  ds_read_b64_tr_b16 v[58:59], v18 offset:35328
  ds_read_b64_tr_b16 v[60:61], v19 offset:34816
  ds_read_b64_tr_b16 v[62:63], v19 offset:35328
  v_mfma_f32_32x32x16_bf16 v[128:143], v[92:95], v[120:123], v[128:143]
  v_mfma_f32_32x32x16_bf16 v[144:159], v[92:95], v[124:127], v[144:159]
  ds_read_b128 v[40:43], v16 offset:4096
  ds_read_b64_tr_b16 v[64:65], v18 offset:36864
  ds_read_b64_tr_b16 v[66:67], v18 offset:37376
  ds_read_b64_tr_b16 v[68:69], v19 offset:36864
  ds_read_b64_tr_b16 v[70:71], v19 offset:37376
  ds_read_b128 v[44:47], v17 offset:4096
  ds_read_b64_tr_b16 v[72:73], v18 offset:38912
  ds_read_b64_tr_b16 v[74:75], v18 offset:39424
  ds_read_b64_tr_b16 v[76:77], v19 offset:38912
  ds_read_b64_tr_b16 v[78:79], v19 offset:39424
  s_waitcnt lgkmcnt(15)
  v_mfma_f32_32x32x16_bf16 v[128:143], v[32:35], v[48:51], v[128:143]
  v_mfma_f32_32x32x16_bf16 v[144:159], v[32:35], v[52:55], v[144:159]
  s_waitcnt lgkmcnt(10)
  v_mfma_f32_32x32x16_bf16 v[128:143], v[36:39], v[56:59], v[128:143]
  v_mfma_f32_32x32x16_bf16 v[144:159], v[36:39], v[60:63], v[144:159]
  s_waitcnt lgkmcnt(0)
  s_barrier
  ds_read_b128 v[80:83], v14 offset:5120
  ds_read_b64_tr_b16 v[96:97], v18 offset:40960
  ds_read_b64_tr_b16 v[98:99], v18 offset:41472
  ds_read_b64_tr_b16 v[100:101], v19 offset:40960
  ds_read_b64_tr_b16 v[102:103], v19 offset:41472
  v_mfma_f32_32x32x16_bf16 v[128:143], v[40:43], v[64:67], v[128:143]
  v_mfma_f32_32x32x16_bf16 v[144:159], v[40:43], v[68:71], v[144:159]
  ds_read_b128 v[84:87], v15 offset:5120
  ds_read_b64_tr_b16 v[104:105], v18 offset:43008
  ds_read_b64_tr_b16 v[106:107], v18 offset:43520
  ds_read_b64_tr_b16 v[108:109], v19 offset:43008
  ds_read_b64_tr_b16 v[110:111], v19 offset:43520
  v_mfma_f32_32x32x16_bf16 v[128:143], v[44:47], v[72:75], v[128:143]
  v_mfma_f32_32x32x16_bf16 v[144:159], v[44:47], v[76:79], v[144:159]
  ds_read_b128 v[88:91], v16 offset:5120
  ds_read_b64_tr_b16 v[112:113], v18 offset:45056
  ds_read_b64_tr_b16 v[114:115], v18 offset:45568
  ds_read_b64_tr_b16 v[116:117], v19 offset:45056
  ds_read_b64_tr_b16 v[118:119], v19 offset:45568
  ds_read_b128 v[92:95], v17 offset:5120
  ds_read_b64_tr_b16 v[120:121], v18 offset:47104
  ds_read_b64_tr_b16 v[122:123], v18 offset:47616
  ds_read_b64_tr_b16 v[124:125], v19 offset:47104
  ds_read_b64_tr_b16 v[126:127], v19 offset:47616
  s_waitcnt lgkmcnt(15)
  v_mfma_f32_32x32x16_bf16 v[128:143], v[80:83], v[96:99], v[128:143]
  v_mfma_f32_32x32x16_bf16 v[144:159], v[80:83], v[100:103], v[144:159]
  s_waitcnt lgkmcnt(10)
  v_mfma_f32_32x32x16_bf16 v[128:143], v[84:87], v[104:107], v[128:143]
  v_mfma_f32_32x32x16_bf16 v[144:159], v[84:87], v[108:111], v[144:159]
  s_waitcnt lgkmcnt(5)
  v_mfma_f32_32x32x16_bf16 v[128:143], v[88:91], v[112:115], v[128:143]
  v_mfma_f32_32x32x16_bf16 v[144:159], v[88:91], v[116:119], v[144:159]
  s_waitcnt lgkmcnt(0)
  v_mfma_f32_32x32x16_bf16 v[128:143], v[92:95], v[120:123], v[128:143]
  v_mfma_f32_32x32x16_bf16 v[144:159], v[92:95], v[124:127], v[144:159]
  s_nop 10
  v_cvt_pk_bf16_f32 v32, v128, v129
  v_cvt_pk_bf16_f32 v33, v130, v131
  v_cvt_pk_bf16_f32 v34, v132, v133
  v_cvt_pk_bf16_f32 v35, v134, v135
  v_cvt_pk_bf16_f32 v36, v136, v137
  v_cvt_pk_bf16_f32 v37, v138, v139
  v_cvt_pk_bf16_f32 v38, v140, v141
  v_cvt_pk_bf16_f32 v39, v142, v143
  buffer_store_dwordx4 v[32:35], v10, s[16:19], s61 offen offset:0 sc1
  buffer_store_dwordx4 v[36:39], v10, s[16:19], s61 offen offset:2048 sc1
  v_cvt_pk_bf16_f32 v40, v144, v145
  v_cvt_pk_bf16_f32 v41, v146, v147
  v_cvt_pk_bf16_f32 v42, v148, v149
  v_cvt_pk_bf16_f32 v43, v150, v151
  v_cvt_pk_bf16_f32 v44, v152, v153
  v_cvt_pk_bf16_f32 v45, v154, v155
  v_cvt_pk_bf16_f32 v46, v156, v157
  v_cvt_pk_bf16_f32 v47, v158, v159
  buffer_store_dwordx4 v[40:43], v10, s[16:19], s61 offen offset:1024 sc1
  buffer_store_dwordx4 v[44:47], v10, s[16:19], s61 offen offset:3072 sc1
  v_mov_b32 v24, 0
  v_mov_b32 v25, 0
  v_dot2c_f32_bf16 v24, s37, v32
  v_dot2c_f32_bf16 v25, s37, v40
  v_dot2c_f32_bf16 v24, s37, v33
  v_dot2c_f32_bf16 v25, s37, v41
  v_dot2c_f32_bf16 v24, s37, v34
  v_dot2c_f32_bf16 v25, s37, v42
  v_dot2c_f32_bf16 v24, s37, v35
  v_dot2c_f32_bf16 v25, s37, v43
  v_dot2c_f32_bf16 v24, s37, v36
  v_dot2c_f32_bf16 v25, s37, v44
  v_dot2c_f32_bf16 v24, s37, v37
  v_dot2c_f32_bf16 v25, s37, v45
  v_dot2c_f32_bf16 v24, s37, v38
  v_dot2c_f32_bf16 v25, s37, v46
  v_dot2c_f32_bf16 v24, s37, v39
  v_dot2c_f32_bf16 v25, s37, v47
  s_nop 1
  v_mov_b32 v26, v24
  v_mov_b32 v27, v25
  s_nop 0
  v_permlane32_swap_b32 v24, v26
  v_permlane32_swap_b32 v25, v27
  v_add_f32 v24, v26, v24
  v_add_f32 v25, v27, v25
  v_cvt_pk_bf16_f32 v26, v24, v24
  v_cvt_pk_bf16_f32 v27, v25, v25
  v_lshlrev_b32 v26, 16, v26
  v_lshlrev_b32 v27, 16, v27
  v_sub_f32 v26, v24, v26
  v_sub_f32 v27, v25, v27
  v_cvt_pk_bf16_f32 v28, v24, v26
  v_cvt_pk_bf16_f32 v29, v25, v27
  s_mov_b32 exec_hi, 0
  buffer_store_dword v28, v30, s[16:19], s62 offen offset:0 sc1
  buffer_store_dword v29, v30, s[16:19], s62 offen offset:128 sc1
  s_mov_b32 exec_hi, -1
W_c4:
  s_waitcnt vmcnt(0) lgkmcnt(0)
  s_mul_i32 s44, s44, 0x9e3779b1
  s_add_u32 s44, s44, 0x7f4a7c15
  s_add_u32 s45, s45, s44
  s_barrier
  s_cmp_lg_u32 s41, 0
  s_cbranch_scc1 f0_12
  s_mov_b64 exec, 15
  v_lshl_add_u32 v48, v1, 4, s63
  v_mov_b32 v50, s44
  v_mov_b32 v51, s44
  v_mov_b32 v52, s44
  v_mov_b32 v53, s44
  buffer_store_dwordx4 v[50:53], v48, s[16:19], s64 offen sc0 sc1
  s_mov_b64 exec, -1
f0_12:
  s_branch W_done2
W_c0:
  s_mul_i32 s34, s55, 24
  s_lshl_b32 s61, s52, 2
  s_add_u32 s34, s34, s61
  v_bfe_u32 v4, v1, 4, 1
  v_add_u32 v4, s34, v4
  v_and_b32 v7, 15, v1
  v_lshlrev_b32 v7, 4, v7
  s_lshl_b32 s61, s51, 2
  s_add_u32 s61, s61, s41
  s_mul_i32 s61, s61, 3072
  s_add_u32 s61, s61, 4063232
  s_lshl_b32 s62, s51, 2
  s_add_u32 s62, s62, s41
  s_mul_i32 s62, s62, 192
  s_add_u32 s62, s62, 4100096
  v_add_u32 v5, 0, v4
  v_mul_u32_u24 v6, 43, v5
  v_lshrrev_b32 v6, 7, v6
  v_mul_u32_u24 v8, 3, v6
  v_sub_u32 v5, v5, v8
  v_mul_u32_u24 v6, 39936, v6
  v_lshl_add_u32 v160, v5, 6, v6
  v_lshl_add_u32 v6, v5, 10, v6
  v_add_u32 v6, v6, v7
  v_lshl_add_u32 v162, v3, 8, v6
  v_lshrrev_b32 v6, 2, v7
  v_add_u32 v160, v160, v6
  v_add_u32 v5, 2, v4
  v_mul_u32_u24 v6, 43, v5
  v_lshrrev_b32 v6, 7, v6
  v_mul_u32_u24 v8, 3, v6
  v_sub_u32 v5, v5, v8
  v_mul_u32_u24 v6, 39936, v6
  v_lshl_add_u32 v161, v5, 6, v6
  v_lshl_add_u32 v6, v5, 10, v6
  v_add_u32 v6, v6, v7
  v_lshl_add_u32 v163, v3, 8, v6
  v_lshrrev_b32 v6, 2, v7
  v_add_u32 v161, v161, v6
  s_cmp_eq_u32 s55, 1
  s_cbranch_scc1 W_c1
  v_lshrrev_b32 v5, 3, v2
  v_mul_u32_u24 v5, 6144, v5
  v_and_b32 v6, 7, v2
  v_lshl_add_u32 v5, v6, 7, v5
  v_bfe_u32 v6, v2, 1, 3
  v_xor_b32 v6, v6, v3
  v_lshl_add_u32 v5, v6, 4, v5
  v_add_u32 v18, 98304, v5
  v_xor_b32 v19, 32, v18
  v_xor_b32 v20, 64, v18
  v_xor_b32 v21, 96, v18
  s_barrier
  ds_read_b128 v[32:35], v14 offset:0
  ds_read_b128 v[48:51], v18 offset:0
  ds_read_b128 v[52:55], v18 offset:24576
  ds_read_b128 v[36:39], v15 offset:0
  ds_read_b128 v[56:59], v19 offset:0
  ds_read_b128 v[60:63], v19 offset:24576
  ds_read_b128 v[40:43], v16 offset:0
  ds_read_b128 v[64:67], v20 offset:0
  ds_read_b128 v[68:71], v20 offset:24576
  ds_read_b128 v[44:47], v17 offset:0
  ds_read_b128 v[72:75], v21 offset:0
  ds_read_b128 v[76:79], v21 offset:24576
  s_waitcnt lgkmcnt(9)
  v_mfma_f32_32x32x16_bf16 v[128:143], v[32:35], v[48:51], 0
  v_mfma_f32_32x32x16_bf16 v[144:159], v[32:35], v[52:55], 0
  s_waitcnt lgkmcnt(6)
  v_mfma_f32_32x32x16_bf16 v[128:143], v[36:39], v[56:59], v[128:143]
  v_mfma_f32_32x32x16_bf16 v[144:159], v[36:39], v[60:63], v[144:159]
  s_waitcnt lgkmcnt(0)
  s_barrier
  ds_read_b128 v[80:83], v14 offset:1024
  ds_read_b128 v[96:99], v18 offset:1024
  ds_read_b128 v[100:103], v18 offset:25600
  v_mfma_f32_32x32x16_bf16 v[128:143], v[40:43], v[64:67], v[128:143]
  v_mfma_f32_32x32x16_bf16 v[144:159], v[40:43], v[68:71], v[144:159]
  ds_read_b128 v[84:87], v15 offset:1024
  ds_read_b128 v[104:107], v19 offset:1024
  ds_read_b128 v[108:111], v19 offset:25600
  v_mfma_f32_32x32x16_bf16 v[128:143], v[44:47], v[72:75], v[128:143]
  v_mfma_f32_32x32x16_bf16 v[144:159], v[44:47], v[76:79], v[144:159]
  ds_read_b128 v[88:91], v16 offset:1024
  ds_read_b128 v[112:115], v20 offset:1024
  ds_read_b128 v[116:119], v20 offset:25600
  ds_read_b128 v[92:95], v17 offset:1024
  ds_read_b128 v[120:123], v21 offset:1024
  ds_read_b128 v[124:127], v21 offset:25600
  s_waitcnt lgkmcnt(9)
  v_mfma_f32_32x32x16_bf16 v[128:143], v[80:83], v[96:99], v[128:143]
  v_mfma_f32_32x32x16_bf16 v[144:159], v[80:83], v[100:103], v[144:159]
  s_waitcnt lgkmcnt(6)
  v_mfma_f32_32x32x16_bf16 v[128:143], v[84:87], v[104:107], v[128:143]
  v_mfma_f32_32x32x16_bf16 v[144:159], v[84:87], v[108:111], v[144:159]
  s_waitcnt lgkmcnt(0)
  s_barrier
  ds_read_b128 v[32:35], v14 offset:2048
  ds_read_b128 v[48:51], v18 offset:2048
  ds_read_b128 v[52:55], v18 offset:26624
  v_mfma_f32_32x32x16_bf16 v[128:143], v[88:91], v[112:115], v[128:143]
  v_mfma_f32_32x32x16_bf16 v[144:159], v[88:91], v[116:119], v[144:159]
  ds_read_b128 v[36:39], v15 offset:2048
  ds_read_b128 v[56:59], v19 offset:2048
  ds_read_b128 v[60:63], v19 offset:26624
  v_mfma_f32_32x32x16_bf16 v[128:143], v[92:95], v[120:123], v[128:143]
  v_mfma_f32_32x32x16_bf16 v[144:159], v[92:95], v[124:127], v[144:159]
  ds_read_b128 v[40:43], v16 offset:2048
  ds_read_b128 v[64:67], v20 offset:2048
  ds_read_b128 v[68:71], v20 offset:26624
  ds_read_b128 v[44:47], v17 offset:2048
  ds_read_b128 v[72:75], v21 offset:2048
  ds_read_b128 v[76:79], v21 offset:26624
  s_waitcnt lgkmcnt(9)
  v_mfma_f32_32x32x16_bf16 v[128:143], v[32:35], v[48:51], v[128:143]
  v_mfma_f32_32x32x16_bf16 v[144:159], v[32:35], v[52:55], v[144:159]
  s_waitcnt lgkmcnt(6)
  v_mfma_f32_32x32x16_bf16 v[128:143], v[36:39], v[56:59], v[128:143]
  v_mfma_f32_32x32x16_bf16 v[144:159], v[36:39], v[60:63], v[144:159]
  s_waitcnt lgkmcnt(0)
  s_barrier
  ds_read_b128 v[80:83], v14 offset:3072
  ds_read_b128 v[96:99], v18 offset:3072
  ds_read_b128 v[100:103], v18 offset:27648
  v_mfma_f32_32x32x16_bf16 v[128:143], v[40:43], v[64:67], v[128:143]
  v_mfma_f32_32x32x16_bf16 v[144:159], v[40:43], v[68:71], v[144:159]
  ds_read_b128 v[84:87], v15 offset:3072
  ds_read_b128 v[104:107], v19 offset:3072
  ds_read_b128 v[108:111], v19 offset:27648
  v_mfma_f32_32x32x16_bf16 v[128:143], v[44:47], v[72:75], v[128:143]
  v_mfma_f32_32x32x16_bf16 v[144:159], v[44:47], v[76:79], v[144:159]
  ds_read_b128 v[88:91], v16 offset:3072
  ds_read_b128 v[112:115], v20 offset:3072
  ds_read_b128 v[116:119], v20 offset:27648
  ds_read_b128 v[92:95], v17 offset:3072
  ds_read_b128 v[120:123], v21 offset:3072
  ds_read_b128 v[124:127], v21 offset:27648
  s_waitcnt lgkmcnt(9)
  v_mfma_f32_32x32x16_bf16 v[128:143], v[80:83], v[96:99], v[128:143]
  v_mfma_f32_32x32x16_bf16 v[144:159], v[80:83], v[100:103], v[144:159]
  s_waitcnt lgkmcnt(6)
  v_mfma_f32_32x32x16_bf16 v[128:143], v[84:87], v[104:107], v[128:143]
  v_mfma_f32_32x32x16_bf16 v[144:159], v[84:87], v[108:111], v[144:159]
  s_waitcnt lgkmcnt(0)
  s_barrier
  ds_read_b128 v[32:35], v14 offset:4096
  ds_read_b128 v[48:51], v18 offset:4096
  ds_read_b128 v[52:55], v18 offset:28672
  v_mfma_f32_32x32x16_bf16 v[128:143], v[88:91], v[112:115], v[128:143]
  v_mfma_f32_32x32x16_bf16 v[144:159], v[88:91], v[116:119], v[144:159]
  ds_read_b128 v[36:39], v15 offset:4096
  ds_read_b128 v[56:59], v19 offset:4096
  ds_read_b128 v[60:63], v19 offset:28672
  v_mfma_f32_32x32x16_bf16 v[128:143], v[92:95], v[120:123], v[128:143]
  v_mfma_f32_32x32x16_bf16 v[144:159], v[92:95], v[124:127], v[144:159]
  ds_read_b128 v[40:43], v16 offset:4096
  ds_read_b128 v[64:67], v20 offset:4096
  ds_read_b128 v[68:71], v20 offset:28672
  ds_read_b128 v[44:47], v17 offset:4096
  ds_read_b128 v[72:75], v21 offset:4096
  ds_read_b128 v[76:79], v21 offset:28672
  s_waitcnt lgkmcnt(9)
  v_mfma_f32_32x32x16_bf16 v[128:143], v[32:35], v[48:51], v[128:143]
  v_mfma_f32_32x32x16_bf16 v[144:159], v[32:35], v[52:55], v[144:159]
  s_waitcnt lgkmcnt(6)
  v_mfma_f32_32x32x16_bf16 v[128:143], v[36:39], v[56:59], v[128:143]
  v_mfma_f32_32x32x16_bf16 v[144:159], v[36:39], v[60:63], v[144:159]
  s_waitcnt lgkmcnt(0)
  s_barrier
  ds_read_b128 v[80:83], v14 offset:5120
  ds_read_b128 v[96:99], v18 offset:5120
  ds_read_b128 v[100:103], v18 offset:29696
  v_mfma_f32_32x32x16_bf16 v[128:143], v[40:43], v[64:67], v[128:143]
  v_mfma_f32_32x32x16_bf16 v[144:159], v[40:43], v[68:71], v[144:159]
  ds_read_b128 v[84:87], v15 offset:5120
  ds_read_b128 v[104:107], v19 offset:5120
  ds_read_b128 v[108:111], v19 offset:29696
  v_mfma_f32_32x32x16_bf16 v[128:143], v[44:47], v[72:75], v[128:143]
  v_mfma_f32_32x32x16_bf16 v[144:159], v[44:47], v[76:79], v[144:159]
  ds_read_b128 v[88:91], v16 offset:5120
  ds_read_b128 v[112:115], v20 offset:5120
  ds_read_b128 v[116:119], v20 offset:29696
  ds_read_b128 v[92:95], v17 offset:5120
  ds_read_b128 v[120:123], v21 offset:5120
  ds_read_b128 v[124:127], v21 offset:29696
  s_waitcnt lgkmcnt(9)
  v_mfma_f32_32x32x16_bf16 v[128:143], v[80:83], v[96:99], v[128:143]
  v_mfma_f32_32x32x16_bf16 v[144:159], v[80:83], v[100:103], v[144:159]
  s_waitcnt lgkmcnt(6)
  v_mfma_f32_32x32x16_bf16 v[128:143], v[84:87], v[104:107], v[128:143]
  v_mfma_f32_32x32x16_bf16 v[144:159], v[84:87], v[108:111], v[144:159]
  s_waitcnt lgkmcnt(3)
  v_mfma_f32_32x32x16_bf16 v[128:143], v[88:91], v[112:115], v[128:143]
  v_mfma_f32_32x32x16_bf16 v[144:159], v[88:91], v[116:119], v[144:159]
  s_waitcnt lgkmcnt(0)
  v_mfma_f32_32x32x16_bf16 v[128:143], v[92:95], v[120:123], v[128:143]
  v_mfma_f32_32x32x16_bf16 v[144:159], v[92:95], v[124:127], v[144:159]
  s_branch W_c2
W_c1:
  v_and_b32 v7, 3, v1
  v_lshl_add_u32 v4, v7, 3, v12
  v_add_u32 v18, 98304, v4
  v_xor_b32 v19, 64, v18
  s_barrier
  ds_read_b128 v[32:35], v14 offset:0
  ds_read_b64_tr_b16 v[48:49], v18 offset:0
  ds_read_b64_tr_b16 v[50:51], v18 offset:512
  ds_read_b64_tr_b16 v[52:53], v19 offset:0
  ds_read_b64_tr_b16 v[54:55], v19 offset:512
  ds_read_b128 v[36:39], v15 offset:0
  ds_read_b64_tr_b16 v[56:57], v18 offset:2048
  ds_read_b64_tr_b16 v[58:59], v18 offset:2560
  ds_read_b64_tr_b16 v[60:61], v19 offset:2048
  ds_read_b64_tr_b16 v[62:63], v19 offset:2560
  ds_read_b128 v[40:43], v16 offset:0
  ds_read_b64_tr_b16 v[64:65], v18 offset:4096
  ds_read_b64_tr_b16 v[66:67], v18 offset:4608
  ds_read_b64_tr_b16 v[68:69], v19 offset:4096
  ds_read_b64_tr_b16 v[70:71], v19 offset:4608
  ds_read_b128 v[44:47], v17 offset:0
  ds_read_b64_tr_b16 v[72:73], v18 offset:6144
  ds_read_b64_tr_b16 v[74:75], v18 offset:6656
  ds_read_b64_tr_b16 v[76:77], v19 offset:6144
  ds_read_b64_tr_b16 v[78:79], v19 offset:6656
  s_waitcnt lgkmcnt(15)
  v_mfma_f32_32x32x16_bf16 v[128:143], v[32:35], v[48:51], 0
  v_mfma_f32_32x32x16_bf16 v[144:159], v[32:35], v[52:55], 0
  s_waitcnt lgkmcnt(10)
  v_mfma_f32_32x32x16_bf16 v[128:143], v[36:39], v[56:59], v[128:143]
  v_mfma_f32_32x32x16_bf16 v[144:159], v[36:39], v[60:63], v[144:159]
  s_waitcnt lgkmcnt(0)
  s_barrier
  ds_read_b128 v[80:83], v14 offset:1024
  ds_read_b64_tr_b16 v[96:97], v18 offset:8192
  ds_read_b64_tr_b16 v[98:99], v18 offset:8704
  ds_read_b64_tr_b16 v[100:101], v19 offset:8192
  ds_read_b64_tr_b16 v[102:103], v19 offset:8704
  v_mfma_f32_32x32x16_bf16 v[128:143], v[40:43], v[64:67], v[128:143]
  v_mfma_f32_32x32x16_bf16 v[144:159], v[40:43], v[68:71], v[144:159]
  ds_read_b128 v[84:87], v15 offset:1024
  ds_read_b64_tr_b16 v[104:105], v18 offset:10240
  ds_read_b64_tr_b16 v[106:107], v18 offset:10752
  ds_read_b64_tr_b16 v[108:109], v19 offset:10240
  ds_read_b64_tr_b16 v[110:111], v19 offset:10752
  v_mfma_f32_32x32x16_bf16 v[128:143], v[44:47], v[72:75], v[128:143]
  v_mfma_f32_32x32x16_bf16 v[144:159], v[44:47], v[76:79], v[144:159]
  ds_read_b128 v[88:91], v16 offset:1024
  ds_read_b64_tr_b16 v[112:113], v18 offset:12288
  ds_read_b64_tr_b16 v[114:115], v18 offset:12800
  ds_read_b64_tr_b16 v[116:117], v19 offset:12288
  ds_read_b64_tr_b16 v[118:119], v19 offset:12800
  ds_read_b128 v[92:95], v17 offset:1024
  ds_read_b64_tr_b16 v[120:121], v18 offset:14336
  ds_read_b64_tr_b16 v[122:123], v18 offset:14848
  ds_read_b64_tr_b16 v[124:125], v19 offset:14336
  ds_read_b64_tr_b16 v[126:127], v19 offset:14848
  s_waitcnt lgkmcnt(15)
  v_mfma_f32_32x32x16_bf16 v[128:143], v[80:83], v[96:99], v[128:143]
  v_mfma_f32_32x32x16_bf16 v[144:159], v[80:83], v[100:103], v[144:159]
  s_waitcnt lgkmcnt(10)
  v_mfma_f32_32x32x16_bf16 v[128:143], v[84:87], v[104:107], v[128:143]
  v_mfma_f32_32x32x16_bf16 v[144:159], v[84:87], v[108:111], v[144:159]
  s_waitcnt lgkmcnt(0)
  s_barrier
  ds_read_b128 v[32:35], v14 offset:2048
  ds_read_b64_tr_b16 v[48:49], v18 offset:16384
  ds_read_b64_tr_b16 v[50:51], v18 offset:16896
  ds_read_b64_tr_b16 v[52:53], v19 offset:16384
  ds_read_b64_tr_b16 v[54:55], v19 offset:16896
  v_mfma_f32_32x32x16_bf16 v[128:143], v[88:91], v[112:115], v[128:143]
  v_mfma_f32_32x32x16_bf16 v[144:159], v[88:91], v[116:119], v[144:159]
  ds_read_b128 v[36:39], v15 offset:2048
  ds_read_b64_tr_b16 v[56:57], v18 offset:18432
  ds_read_b64_tr_b16 v[58:59], v18 offset:18944
  ds_read_b64_tr_b16 v[60:61], v19 offset:18432
  ds_read_b64_tr_b16 v[62:63], v19 offset:18944
  v_mfma_f32_32x32x16_bf16 v[128:143], v[92:95], v[120:123], v[128:143]
  v_mfma_f32_32x32x16_bf16 v[144:159], v[92:95], v[124:127], v[144:159]
  ds_read_b128 v[40:43], v16 offset:2048
  ds_read_b64_tr_b16 v[64:65], v18 offset:20480
  ds_read_b64_tr_b16 v[66:67], v18 offset:20992
  ds_read_b64_tr_b16 v[68:69], v19 offset:20480
  ds_read_b64_tr_b16 v[70:71], v19 offset:20992
  ds_read_b128 v[44:47], v17 offset:2048
  ds_read_b64_tr_b16 v[72:73], v18 offset:22528
  ds_read_b64_tr_b16 v[74:75], v18 offset:23040
  ds_read_b64_tr_b16 v[76:77], v19 offset:22528
  ds_read_b64_tr_b16 v[78:79], v19 offset:23040
  s_waitcnt lgkmcnt(15)
  v_mfma_f32_32x32x16_bf16 v[128:143], v[32:35], v[48:51], v[128:143]
  v_mfma_f32_32x32x16_bf16 v[144:159], v[32:35], v[52:55], v[144:159]
  s_waitcnt lgkmcnt(10)
  v_mfma_f32_32x32x16_bf16 v[128:143], v[36:39], v[56:59], v[128:143]
  v_mfma_f32_32x32x16_bf16 v[144:159], v[36:39], v[60:63], v[144:159]
  s_waitcnt lgkmcnt(0)
  s_barrier
  ds_read_b128 v[80:83], v14 offset:3072
  ds_read_b64_tr_b16 v[96:97], v18 offset:24576
  ds_read_b64_tr_b16 v[98:99], v18 offset:25088
  ds_read_b64_tr_b16 v[100:101], v19 offset:24576
  ds_read_b64_tr_b16 v[102:103], v19 offset:25088
  v_mfma_f32_32x32x16_bf16 v[128:143], v[40:43], v[64:67], v[128:143]
  v_mfma_f32_32x32x16_bf16 v[144:159], v[40:43], v[68:71], v[144:159]
  ds_read_b128 v[84:87], v15 offset:3072
  ds_read_b64_tr_b16 v[104:105], v18 offset:26624
  ds_read_b64_tr_b16 v[106:107], v18 offset:27136
  ds_read_b64_tr_b16 v[108:109], v19 offset:26624
  ds_read_b64_tr_b16 v[110:111], v19 offset:27136
  v_mfma_f32_32x32x16_bf16 v[128:143], v[44:47], v[72:75], v[128:143]
  v_mfma_f32_32x32x16_bf16 v[144:159], v[44:47], v[76:79], v[144:159]
  ds_read_b128 v[88:91], v16 offset:3072
  ds_read_b64_tr_b16 v[112:113], v18 offset:28672
  ds_read_b64_tr_b16 v[114:115], v18 offset:29184
  ds_read_b64_tr_b16 v[116:117], v19 offset:28672
  ds_read_b64_tr_b16 v[118:119], v19 offset:29184
  ds_read_b128 v[92:95], v17 offset:3072
  ds_read_b64_tr_b16 v[120:121], v18 offset:30720
  ds_read_b64_tr_b16 v[122:123], v18 offset:31232
  ds_read_b64_tr_b16 v[124:125], v19 offset:30720
  ds_read_b64_tr_b16 v[126:127], v19 offset:31232
  s_waitcnt lgkmcnt(15)
  v_mfma_f32_32x32x16_bf16 v[128:143], v[80:83], v[96:99], v[128:143]
  v_mfma_f32_32x32x16_bf16 v[144:159], v[80:83], v[100:103], v[144:159]
  s_waitcnt lgkmcnt(10)
  v_mfma_f32_32x32x16_bf16 v[128:143], v[84:87], v[104:107], v[128:143]
  v_mfma_f32_32x32x16_bf16 v[144:159], v[84:87], v[108:111], v[144:159]
  s_waitcnt lgkmcnt(0)
  s_barrier
  ds_read_b128 v[32:35], v14 offset:4096
  ds_read_b64_tr_b16 v[48:49], v18 offset:32768
  ds_read_b64_tr_b16 v[50:51], v18 offset:33280
  ds_read_b64_tr_b16 v[52:53], v19 offset:32768
  ds_read_b64_tr_b16 v[54:55], v19 offset:33280
  v_mfma_f32_32x32x16_bf16 v[128:143], v[88:91], v[112:115], v[128:143]
  v_mfma_f32_32x32x16_bf16 v[144:159], v[88:91], v[116:119], v[144:159]
  ds_read_b128 v[36:39], v15 offset:4096
  ds_read_b64_tr_b16 v[56:57], v18 offset:34816
  ds_read_b64_tr_b16 v[58:59], v18 offset:35328
  ds_read_b64_tr_b16 v[60:61], v19 offset:34816
  ds_read_b64_tr_b16 v[62:63], v19 offset:35328
  v_mfma_f32_32x32x16_bf16 v[128:143], v[92:95], v[120:123], v[128:143]
  v_mfma_f32_32x32x16_bf16 v[144:159], v[92:95], v[124:127], v[144:159]
  ds_read_b128 v[40:43], v16 offset:4096
  ds_read_b64_tr_b16 v[64:65], v18 offset:36864
  ds_read_b64_tr_b16 v[66:67], v18 offset:37376
  ds_read_b64_tr_b16 v[68:69], v19 offset:36864
  ds_read_b64_tr_b16 v[70:71], v19 offset:37376
  ds_read_b128 v[44:47], v17 offset:4096
  ds_read_b64_tr_b16 v[72:73], v18 offset:38912
  ds_read_b64_tr_b16 v[74:75], v18 offset:39424
  ds_read_b64_tr_b16 v[76:77], v19 offset:38912
  ds_read_b64_tr_b16 v[78:79], v19 offset:39424
  s_waitcnt lgkmcnt(15)
  v_mfma_f32_32x32x16_bf16 v[128:143], v[32:35], v[48:51], v[128:143]
  v_mfma_f32_32x32x16_bf16 v[144:159], v[32:35], v[52:55], v[144:159]
  s_waitcnt lgkmcnt(10)
  v_mfma_f32_32x32x16_bf16 v[128:143], v[36:39], v[56:59], v[128:143]
  v_mfma_f32_32x32x16_bf16 v[144:159], v[36:39], v[60:63], v[144:159]
  s_waitcnt lgkmcnt(0)
  s_barrier
  ds_read_b128 v[80:83], v14 offset:5120
  ds_read_b64_tr_b16 v[96:97], v18 offset:40960
  ds_read_b64_tr_b16 v[98:99], v18 offset:41472
  ds_read_b64_tr_b16 v[100:101], v19 offset:40960
  ds_read_b64_tr_b16 v[102:103], v19 offset:41472
  v_mfma_f32_32x32x16_bf16 v[128:143], v[40:43], v[64:67], v[128:143]
  v_mfma_f32_32x32x16_bf16 v[144:159], v[40:43], v[68:71], v[144:159]
  ds_read_b128 v[84:87], v15 offset:5120
  ds_read_b64_tr_b16 v[104:105], v18 offset:43008
  ds_read_b64_tr_b16 v[106:107], v18 offset:43520
  ds_read_b64_tr_b16 v[108:109], v19 offset:43008
  ds_read_b64_tr_b16 v[110:111], v19 offset:43520
  v_mfma_f32_32x32x16_bf16 v[128:143], v[44:47], v[72:75], v[128:143]
  v_mfma_f32_32x32x16_bf16 v[144:159], v[44:47], v[76:79], v[144:159]
  ds_read_b128 v[88:91], v16 offset:5120
  ds_read_b64_tr_b16 v[112:113], v18 offset:45056
  ds_read_b64_tr_b16 v[114:115], v18 offset:45568
  ds_read_b64_tr_b16 v[116:117], v19 offset:45056
  ds_read_b64_tr_b16 v[118:119], v19 offset:45568
  ds_read_b128 v[92:95], v17 offset:5120
  ds_read_b64_tr_b16 v[120:121], v18 offset:47104
  ds_read_b64_tr_b16 v[122:123], v18 offset:47616
  ds_read_b64_tr_b16 v[124:125], v19 offset:47104
  ds_read_b64_tr_b16 v[126:127], v19 offset:47616
  s_waitcnt lgkmcnt(15)
  v_mfma_f32_32x32x16_bf16 v[128:143], v[80:83], v[96:99], v[128:143]
  v_mfma_f32_32x32x16_bf16 v[144:159], v[80:83], v[100:103], v[144:159]
  s_waitcnt lgkmcnt(10)
  v_mfma_f32_32x32x16_bf16 v[128:143], v[84:87], v[104:107], v[128:143]
  v_mfma_f32_32x32x16_bf16 v[144:159], v[84:87], v[108:111], v[144:159]
  s_waitcnt lgkmcnt(5)
  v_mfma_f32_32x32x16_bf16 v[128:143], v[88:91], v[112:115], v[128:143]
  v_mfma_f32_32x32x16_bf16 v[144:159], v[88:91], v[116:119], v[144:159]
  s_waitcnt lgkmcnt(0)
  v_mfma_f32_32x32x16_bf16 v[128:143], v[92:95], v[120:123], v[128:143]
  v_mfma_f32_32x32x16_bf16 v[144:159], v[92:95], v[124:127], v[144:159]
W_c2:
  s_nop 10
  v_cvt_pk_bf16_f32 v32, v128, v129
  v_cvt_pk_bf16_f32 v33, v130, v131
  v_cvt_pk_bf16_f32 v34, v132, v133
  v_cvt_pk_bf16_f32 v35, v134, v135
  v_cvt_pk_bf16_f32 v36, v136, v137
  v_cvt_pk_bf16_f32 v37, v138, v139
  v_cvt_pk_bf16_f32 v38, v140, v141
  v_cvt_pk_bf16_f32 v39, v142, v143
  buffer_store_dwordx4 v[32:35], v162, s[16:19], s61 offen sc1
  buffer_store_dwordx4 v[36:39], v162, s[16:19], s61 offen offset:512 sc1
  v_cvt_pk_bf16_f32 v40, v144, v145
  v_cvt_pk_bf16_f32 v41, v146, v147
  v_cvt_pk_bf16_f32 v42, v148, v149
  v_cvt_pk_bf16_f32 v43, v150, v151
  v_cvt_pk_bf16_f32 v44, v152, v153
  v_cvt_pk_bf16_f32 v45, v154, v155
  v_cvt_pk_bf16_f32 v46, v156, v157
  v_cvt_pk_bf16_f32 v47, v158, v159
  buffer_store_dwordx4 v[40:43], v163, s[16:19], s61 offen sc1
  buffer_store_dwordx4 v[44:47], v163, s[16:19], s61 offen offset:512 sc1
  v_mov_b32 v24, 0
  v_mov_b32 v25, 0
  v_dot2c_f32_bf16 v24, s37, v32
  v_dot2c_f32_bf16 v25, s37, v40
  v_dot2c_f32_bf16 v24, s37, v33
  v_dot2c_f32_bf16 v25, s37, v41
  v_dot2c_f32_bf16 v24, s37, v34
  v_dot2c_f32_bf16 v25, s37, v42
  v_dot2c_f32_bf16 v24, s37, v35
  v_dot2c_f32_bf16 v25, s37, v43
  v_dot2c_f32_bf16 v24, s37, v36
  v_dot2c_f32_bf16 v25, s37, v44
  v_dot2c_f32_bf16 v24, s37, v37
  v_dot2c_f32_bf16 v25, s37, v45
  v_dot2c_f32_bf16 v24, s37, v38
  v_dot2c_f32_bf16 v25, s37, v46
  v_dot2c_f32_bf16 v24, s37, v39
  v_dot2c_f32_bf16 v25, s37, v47
  s_nop 1
  v_mov_b32 v26, v24
  v_mov_b32 v27, v25
  s_nop 0
  v_permlane32_swap_b32 v24, v26
  v_permlane32_swap_b32 v25, v27
  v_add_f32 v24, v26, v24
  v_add_f32 v25, v27, v25
  v_cvt_pk_bf16_f32 v26, v24, v24
  v_cvt_pk_bf16_f32 v27, v25, v25
  v_lshlrev_b32 v26, 16, v26
  v_lshlrev_b32 v27, 16, v27
  v_sub_f32 v26, v24, v26
  v_sub_f32 v27, v25, v27
  v_cvt_pk_bf16_f32 v28, v24, v26
  v_cvt_pk_bf16_f32 v29, v25, v27
  s_mov_b32 exec_hi, 0
  buffer_store_dword v28, v160, s[16:19], s62 offen sc1
  buffer_store_dword v29, v161, s[16:19], s62 offen sc1
  s_mov_b32 exec_hi, -1
  s_branch W_done
W_ld:
  v_lshrrev_b32 v4, 1, v2
  v_xor_b32 v4, v4, v3
  v_mul_u32_u24 v5, 2304, v2
  v_lshl_add_u32 v12, v4, 4, v5
  v_xor_b32 v13, 64, v12
  v_lshlrev_b32 v4, 1, v2
  v_and_b32 v4, 4, v4
  v_xor_b32 v4, v4, v3
  v_mul_u32_u24 v5, 768, v2
  v_lshl_add_u32 v14, v4, 4, v5
W_l0:
  s_waitcnt lgkmcnt(0)
  s_mul_i32 s35, s44, 0x9e3779b1
  s_add_u32 s35, s35, 0x7f4a7c15
  s_add_u32 s35, s35, s45
  s_lshl_b32 s34, s40, 7
  s_add_u32 s34, s34, 8019968
  v_mov_b32 v20, 0
  s_mov_b32 s56, 16
W_pw:
  buffer_load_dword v21, v20, s[16:19], s34 offen sc1
  s_waitcnt vmcnt(0)
  v_cmp_ne_u32 vcc, s35, v21
  s_cbranch_vccz W_go
  s_sub_u32 s56, s56, 1
  s_cmp_lg_u32 s56, 0
  s_cbranch_scc1 W_pw
W_go:
  s_mov_b32 s8, s30
  s_mov_b32 s9, s31
  s_mov_b32 s10, 884736
  s_mov_b32 s11, 0x20000
  s_mov_b32 s12, s36
  s_mov_b32 s13, s37
  s_mov_b32 s14, 294912
  s_mov_b32 s15, 0x20000
  s_lshl_b32 s34, s51, 2
  s_add_u32 s34, s34, s41
  s_mul_i32 s53, s34, 73728
  s_mul_i32 s35, s55, 1536
  s_add_u32 s53, s53, s35
  s_mul_i32 s57, s41, 24576
  s_cmp_eq_u32 s55, 1
  s_cbranch_scc1 W_l1
  s_lshl_b32 s34, s52, 2
  s_add_u32 s34, s34, s41
  s_mul_i32 s54, s34, 36864
  s_add_u32 s54, s54, 768
  s_mul_i32 s58, s41, 12288
  s_mul_i32 s34, s51, 3
  s_lshr_b32 s34, s34, 1
  s_add_u32 s34, s34, s52
  s_mov_b32 s48, s34
  s_cmp_ge_u32 s48, 6
  s_cselect_b32 s35, 6, 0
  s_sub_u32 s48, s48, s35
  s_lshl_b32 s35, s48, 7
  s_add_u32 s59, s53, s35
  s_add_u32 s65, s54, s35
  s_add_u32 s48, s48, 1
  s_add_u32 s56, s59, 0
  s_add_u32 m0, s57, 0
  s_nop 0
  buffer_load_dwordx4 v12, s[8:11], s56 offen lds
  s_add_u32 s56, s59, 18432
  s_add_u32 m0, s57, 6144
  s_nop 0
  buffer_load_dwordx4 v13, s[8:11], s56 offen lds
  s_add_u32 s56, s59, 36864
  s_add_u32 m0, s57, 12288
  s_nop 0
  buffer_load_dwordx4 v12, s[8:11], s56 offen lds
  s_add_u32 s56, s59, 55296
  s_add_u32 m0, s57, 18432
  s_nop 0
  buffer_load_dwordx4 v13, s[8:11], s56 offen lds
  s_add_u32 s56, s65, 0
  s_add_u32 m0, s58, 98304
  s_nop 0
  buffer_load_dwordx4 v12, s[8:11], s56 offen lds
  s_add_u32 s56, s65, 18432
  s_add_u32 m0, s58, 104448
  s_nop 0
  buffer_load_dwordx4 v13, s[8:11], s56 offen lds
  s_cmp_ge_u32 s48, 6
  s_cselect_b32 s35, 6, 0
  s_sub_u32 s48, s48, s35
  s_lshl_b32 s35, s48, 7
  s_add_u32 s60, s53, s35
  s_add_u32 s66, s54, s35
  s_add_u32 s48, s48, 1
  s_add_u32 s56, s60, 0
  s_add_u32 m0, s57, 1024
  s_nop 0
  buffer_load_dwordx4 v12, s[8:11], s56 offen lds
  s_add_u32 s56, s60, 18432
  s_add_u32 m0, s57, 7168
  s_nop 0
  buffer_load_dwordx4 v13, s[8:11], s56 offen lds
  s_add_u32 s56, s60, 36864
  s_add_u32 m0, s57, 13312
  s_nop 0
  buffer_load_dwordx4 v12, s[8:11], s56 offen lds
  s_add_u32 s56, s60, 55296
  s_add_u32 m0, s57, 19456
  s_nop 0
  buffer_load_dwordx4 v13, s[8:11], s56 offen lds
  s_add_u32 s56, s66, 0
  s_add_u32 m0, s58, 99328
  s_nop 0
  buffer_load_dwordx4 v12, s[8:11], s56 offen lds
  s_add_u32 s56, s66, 18432
  s_add_u32 m0, s58, 105472
  s_nop 0
  buffer_load_dwordx4 v13, s[8:11], s56 offen lds
  s_cmp_ge_u32 s48, 6
  s_cselect_b32 s35, 6, 0
  s_sub_u32 s48, s48, s35
  s_lshl_b32 s35, s48, 7
  s_add_u32 s61, s53, s35
  s_add_u32 s67, s54, s35
  s_add_u32 s48, s48, 1
  s_add_u32 s56, s61, 0
  s_add_u32 m0, s57, 2048
  s_nop 0
  buffer_load_dwordx4 v12, s[8:11], s56 offen lds
  s_add_u32 s56, s61, 18432
  s_add_u32 m0, s57, 8192
  s_nop 0
  buffer_load_dwordx4 v13, s[8:11], s56 offen lds
  s_add_u32 s56, s61, 36864
  s_add_u32 m0, s57, 14336
  s_nop 0
  buffer_load_dwordx4 v12, s[8:11], s56 offen lds
  s_add_u32 s56, s61, 55296
  s_add_u32 m0, s57, 20480
  s_nop 0
  buffer_load_dwordx4 v13, s[8:11], s56 offen lds
  s_add_u32 s56, s67, 0
  s_add_u32 m0, s58, 100352
  s_nop 0
  buffer_load_dwordx4 v12, s[8:11], s56 offen lds
  s_add_u32 s56, s67, 18432
  s_add_u32 m0, s58, 106496
  s_nop 0
  buffer_load_dwordx4 v13, s[8:11], s56 offen lds
  s_cmp_ge_u32 s48, 6
  s_cselect_b32 s35, 6, 0
  s_sub_u32 s48, s48, s35
  s_lshl_b32 s35, s48, 7
  s_add_u32 s62, s53, s35
  s_add_u32 s68, s54, s35
  s_add_u32 s48, s48, 1
  s_cmp_ge_u32 s48, 6
  s_cselect_b32 s35, 6, 0
  s_sub_u32 s48, s48, s35
  s_lshl_b32 s35, s48, 7
  s_add_u32 s63, s53, s35
  s_add_u32 s69, s54, s35
  s_add_u32 s48, s48, 1
  s_cmp_ge_u32 s48, 6
  s_cselect_b32 s35, 6, 0
  s_sub_u32 s48, s48, s35
  s_lshl_b32 s35, s48, 7
  s_add_u32 s64, s53, s35
  s_add_u32 s3, s54, s35
  s_add_u32 s48, s48, 1
  s_waitcnt vmcnt(12)
  s_barrier
  s_add_u32 s56, s62, 0
  s_add_u32 m0, s57, 3072
  s_nop 0
  buffer_load_dwordx4 v12, s[8:11], s56 offen lds
  s_add_u32 s56, s62, 18432
  s_add_u32 m0, s57, 9216
  s_nop 0
  buffer_load_dwordx4 v13, s[8:11], s56 offen lds
  s_add_u32 s56, s62, 36864
  s_add_u32 m0, s57, 15360
  s_nop 0
  buffer_load_dwordx4 v12, s[8:11], s56 offen lds
  s_add_u32 s56, s62, 55296
  s_add_u32 m0, s57, 21504
  s_nop 0
  buffer_load_dwordx4 v13, s[8:11], s56 offen lds
  s_add_u32 s56, s68, 0
  s_add_u32 m0, s58, 101376
  s_nop 0
  buffer_load_dwordx4 v12, s[8:11], s56 offen lds
  s_add_u32 s56, s68, 18432
  s_add_u32 m0, s58, 107520
  s_nop 0
  buffer_load_dwordx4 v13, s[8:11], s56 offen lds
  s_waitcnt vmcnt(12)
  s_barrier
  s_add_u32 s56, s63, 0
  s_add_u32 m0, s57, 4096
  s_nop 0
  buffer_load_dwordx4 v12, s[8:11], s56 offen lds
  s_add_u32 s56, s63, 18432
  s_add_u32 m0, s57, 10240
  s_nop 0
  buffer_load_dwordx4 v13, s[8:11], s56 offen lds
  s_add_u32 s56, s63, 36864
  s_add_u32 m0, s57, 16384
  s_nop 0
  buffer_load_dwordx4 v12, s[8:11], s56 offen lds
  s_add_u32 s56, s63, 55296
  s_add_u32 m0, s57, 22528
  s_nop 0
  buffer_load_dwordx4 v13, s[8:11], s56 offen lds
  s_add_u32 s56, s69, 0
  s_add_u32 m0, s58, 102400
  s_nop 0
  buffer_load_dwordx4 v12, s[8:11], s56 offen lds
  s_add_u32 s56, s69, 18432
  s_add_u32 m0, s58, 108544
  s_nop 0
  buffer_load_dwordx4 v13, s[8:11], s56 offen lds
  s_waitcnt vmcnt(12)
  s_barrier
  s_add_u32 s56, s64, 0
  s_add_u32 m0, s57, 5120
  s_nop 0
  buffer_load_dwordx4 v12, s[8:11], s56 offen lds
  s_add_u32 s56, s64, 18432
  s_add_u32 m0, s57, 11264
  s_nop 0
  buffer_load_dwordx4 v13, s[8:11], s56 offen lds
  s_add_u32 s56, s64, 36864
  s_add_u32 m0, s57, 17408
  s_nop 0
  buffer_load_dwordx4 v12, s[8:11], s56 offen lds
  s_add_u32 s56, s64, 55296
  s_add_u32 m0, s57, 23552
  s_nop 0
  buffer_load_dwordx4 v13, s[8:11], s56 offen lds
  s_add_u32 s56, s3, 0
  s_add_u32 m0, s58, 103424
  s_nop 0
  buffer_load_dwordx4 v12, s[8:11], s56 offen lds
  s_add_u32 s56, s3, 18432
  s_add_u32 m0, s58, 109568
  s_nop 0
  buffer_load_dwordx4 v13, s[8:11], s56 offen lds
  s_waitcnt vmcnt(12)
  s_barrier
  s_waitcnt vmcnt(6)
  s_barrier
  s_waitcnt vmcnt(0)
  s_barrier
  s_branch W_done
W_l1:
  s_mul_i32 s54, s41, 12288
  s_lshl_b32 s34, s52, 7
  s_add_u32 s54, s54, s34
  s_lshl_b32 s58, s41, 11
  s_mul_i32 s34, s51, 3
  s_lshr_b32 s34, s34, 1
  s_add_u32 s34, s34, s52
  s_mov_b32 s48, s34
  s_cmp_ge_u32 s48, 6
  s_cselect_b32 s35, 6, 0
  s_sub_u32 s48, s48, s35
  s_lshl_b32 s35, s48, 7
  s_add_u32 s59, s53, s35
  s_mul_i32 s35, s48, 49152
  s_add_u32 s65, s54, s35
  s_add_u32 s48, s48, 1
  s_add_u32 s56, s59, 0
  s_add_u32 m0, s57, 0
  s_nop 0
  buffer_load_dwordx4 v12, s[8:11], s56 offen lds
  s_add_u32 s56, s59, 18432
  s_add_u32 m0, s57, 6144
  s_nop 0
  buffer_load_dwordx4 v13, s[8:11], s56 offen lds
  s_add_u32 s56, s59, 36864
  s_add_u32 m0, s57, 12288
  s_nop 0
  buffer_load_dwordx4 v12, s[8:11], s56 offen lds
  s_add_u32 s56, s59, 55296
  s_add_u32 m0, s57, 18432
  s_nop 0
  buffer_load_dwordx4 v13, s[8:11], s56 offen lds
  s_add_u32 s56, s65, 0
  s_add_u32 m0, s58, 98304
  s_nop 0
  buffer_load_dwordx4 v14, s[12:15], s56 offen lds
  s_add_u32 s56, s65, 6144
  s_add_u32 m0, s58, 99328
  s_nop 0
  buffer_load_dwordx4 v14, s[12:15], s56 offen lds
  s_cmp_ge_u32 s48, 6
  s_cselect_b32 s35, 6, 0
  s_sub_u32 s48, s48, s35
  s_lshl_b32 s35, s48, 7
  s_add_u32 s60, s53, s35
  s_mul_i32 s35, s48, 49152
  s_add_u32 s66, s54, s35
  s_add_u32 s48, s48, 1
  s_add_u32 s56, s60, 0
  s_add_u32 m0, s57, 1024
  s_nop 0
  buffer_load_dwordx4 v12, s[8:11], s56 offen lds
  s_add_u32 s56, s60, 18432
  s_add_u32 m0, s57, 7168
  s_nop 0
  buffer_load_dwordx4 v13, s[8:11], s56 offen lds
  s_add_u32 s56, s60, 36864
  s_add_u32 m0, s57, 13312
  s_nop 0
  buffer_load_dwordx4 v12, s[8:11], s56 offen lds
  s_add_u32 s56, s60, 55296
  s_add_u32 m0, s57, 19456
  s_nop 0
  buffer_load_dwordx4 v13, s[8:11], s56 offen lds
  s_add_u32 s56, s66, 0
  s_add_u32 m0, s58, 106496
  s_nop 0
  buffer_load_dwordx4 v14, s[12:15], s56 offen lds
  s_add_u32 s56, s66, 6144
  s_add_u32 m0, s58, 107520
  s_nop 0
  buffer_load_dwordx4 v14, s[12:15], s56 offen lds
  s_cmp_ge_u32 s48, 6
  s_cselect_b32 s35, 6, 0
  s_sub_u32 s48, s48, s35
  s_lshl_b32 s35, s48, 7
  s_add_u32 s61, s53, s35
  s_mul_i32 s35, s48, 49152
  s_add_u32 s67, s54, s35
  s_add_u32 s48, s48, 1
  s_add_u32 s56, s61, 0
  s_add_u32 m0, s57, 2048
  s_nop 0
  buffer_load_dwordx4 v12, s[8:11], s56 offen lds
  s_add_u32 s56, s61, 18432
  s_add_u32 m0, s57, 8192
  s_nop 0
  buffer_load_dwordx4 v13, s[8:11], s56 offen lds
  s_add_u32 s56, s61, 36864
  s_add_u32 m0, s57, 14336
  s_nop 0
  buffer_load_dwordx4 v12, s[8:11], s56 offen lds
  s_add_u32 s56, s61, 55296
  s_add_u32 m0, s57, 20480
  s_nop 0
  buffer_load_dwordx4 v13, s[8:11], s56 offen lds
  s_add_u32 s56, s67, 0
  s_add_u32 m0, s58, 114688
  s_nop 0
  buffer_load_dwordx4 v14, s[12:15], s56 offen lds
  s_add_u32 s56, s67, 6144
  s_add_u32 m0, s58, 115712
  s_nop 0
  buffer_load_dwordx4 v14, s[12:15], s56 offen lds
  s_cmp_ge_u32 s48, 6
  s_cselect_b32 s35, 6, 0
  s_sub_u32 s48, s48, s35
  s_lshl_b32 s35, s48, 7
  s_add_u32 s62, s53, s35
  s_mul_i32 s35, s48, 49152
  s_add_u32 s68, s54, s35
  s_add_u32 s48, s48, 1
  s_cmp_ge_u32 s48, 6
  s_cselect_b32 s35, 6, 0
  s_sub_u32 s48, s48, s35
  s_lshl_b32 s35, s48, 7
  s_add_u32 s63, s53, s35
  s_mul_i32 s35, s48, 49152
  s_add_u32 s69, s54, s35
  s_add_u32 s48, s48, 1
  s_cmp_ge_u32 s48, 6
  s_cselect_b32 s35, 6, 0
  s_sub_u32 s48, s48, s35
  s_lshl_b32 s35, s48, 7
  s_add_u32 s64, s53, s35
  s_mul_i32 s35, s48, 49152
  s_add_u32 s3, s54, s35
  s_add_u32 s48, s48, 1
  s_waitcnt vmcnt(12)
  s_barrier
  s_add_u32 s56, s62, 0
  s_add_u32 m0, s57, 3072
  s_nop 0
  buffer_load_dwordx4 v12, s[8:11], s56 offen lds
  s_add_u32 s56, s62, 18432
  s_add_u32 m0, s57, 9216
  s_nop 0
  buffer_load_dwordx4 v13, s[8:11], s56 offen lds
  s_add_u32 s56, s62, 36864
  s_add_u32 m0, s57, 15360
  s_nop 0
  buffer_load_dwordx4 v12, s[8:11], s56 offen lds
  s_add_u32 s56, s62, 55296
  s_add_u32 m0, s57, 21504
  s_nop 0
  buffer_load_dwordx4 v13, s[8:11], s56 offen lds
  s_add_u32 s56, s68, 0
  s_add_u32 m0, s58, 122880
  s_nop 0
  buffer_load_dwordx4 v14, s[12:15], s56 offen lds
  s_add_u32 s56, s68, 6144
  s_add_u32 m0, s58, 123904
  s_nop 0
  buffer_load_dwordx4 v14, s[12:15], s56 offen lds
  s_waitcnt vmcnt(12)
  s_barrier
  s_add_u32 s56, s63, 0
  s_add_u32 m0, s57, 4096
  s_nop 0
  buffer_load_dwordx4 v12, s[8:11], s56 offen lds
  s_add_u32 s56, s63, 18432
  s_add_u32 m0, s57, 10240
  s_nop 0
  buffer_load_dwordx4 v13, s[8:11], s56 offen lds
  s_add_u32 s56, s63, 36864
  s_add_u32 m0, s57, 16384
  s_nop 0
  buffer_load_dwordx4 v12, s[8:11], s56 offen lds
  s_add_u32 s56, s63, 55296
  s_add_u32 m0, s57, 22528
  s_nop 0
  buffer_load_dwordx4 v13, s[8:11], s56 offen lds
  s_add_u32 s56, s69, 0
  s_add_u32 m0, s58, 131072
  s_nop 0
  buffer_load_dwordx4 v14, s[12:15], s56 offen lds
  s_add_u32 s56, s69, 6144
  s_add_u32 m0, s58, 132096
  s_nop 0
  buffer_load_dwordx4 v14, s[12:15], s56 offen lds
  s_waitcnt vmcnt(12)
  s_barrier
  s_add_u32 s56, s64, 0
  s_add_u32 m0, s57, 5120
  s_nop 0
  buffer_load_dwordx4 v12, s[8:11], s56 offen lds
  s_add_u32 s56, s64, 18432
  s_add_u32 m0, s57, 11264
  s_nop 0
  buffer_load_dwordx4 v13, s[8:11], s56 offen lds
  s_add_u32 s56, s64, 36864
  s_add_u32 m0, s57, 17408
  s_nop 0
  buffer_load_dwordx4 v12, s[8:11], s56 offen lds
  s_add_u32 s56, s64, 55296
  s_add_u32 m0, s57, 23552
  s_nop 0
  buffer_load_dwordx4 v13, s[8:11], s56 offen lds
  s_add_u32 s56, s3, 0
  s_add_u32 m0, s58, 139264
  s_nop 0
  buffer_load_dwordx4 v14, s[12:15], s56 offen lds
  s_add_u32 s56, s3, 6144
  s_add_u32 m0, s58, 140288
  s_nop 0
  buffer_load_dwordx4 v14, s[12:15], s56 offen lds
  s_waitcnt vmcnt(12)
  s_barrier
  s_waitcnt vmcnt(6)
  s_barrier
  s_waitcnt vmcnt(0)
  s_barrier
W_done:
  s_waitcnt vmcnt(0) lgkmcnt(0)
  s_mul_i32 s44, s44, 0x9e3779b1
  s_add_u32 s44, s44, 0x7f4a7c15
  s_add_u32 s45, s45, s44
  s_barrier
  s_cmp_lg_u32 s43, 0
  s_cbranch_scc1 W_done3
W_done2:
  s_lshl_b32 s34, s49, 7
  s_mov_b32 s35, 8036352
  s_cmp_lg_u32 s41, 0
  s_cbranch_scc1 f0_13
  s_mov_b64 exec, 15
  v_lshl_add_u32 v32, v1, 4, s34
  v_mov_b32 v34, s44
  v_mov_b32 v35, s44
  v_mov_b32 v36, s44
  v_mov_b32 v37, s44
  buffer_store_dwordx4 v[34:37], v32, s[16:19], s35 offen sc0 sc1
  s_mov_b64 exec, -1
f0_13:
P2_c:
  s_lshr_b32 s50, s42, 3
  s_lshr_b32 s3, s41, 1
  s_lshr_b32 s52, s42, 1
  s_and_b32 s53, s42, 1
  s_mul_i32 s56, s40, 196608
  s_mul_i32 s35, s41, 12288
  s_add_u32 s56, s56, s35
  s_add_u32 s56, s56, 2359296
  v_lshrrev_b32 v2, 4, v1
  v_and_b32 v3, 15, v1
  v_bfe_u32 v5, v1, 4, 1
  s_and_b32 s51, s42, 7
  s_lshl_b32 s51, s51, 1
  s_and_b32 s34, s41, 1
  s_add_u32 s51, s51, s34
  s_mul_i32 s35, s34, 39936
  v_add_u32 v72, s35, v10
  v_cmp_eq_u32 vcc, 3, v2
  s_nop 1
  v_cndmask_b32 v6, v2, 0, vcc
  v_mul_u32_u24 v6, 768, v6
  v_lshl_add_u32 v6, v3, 2, v6
  s_add_u32 s35, s35, 36864
  v_add_u32 v73, s35, v6
  s_mul_i32 s35, s3, 24576
  s_add_u32 s35, s35, 81920
  v_add_u32 v11, s35, v10
  s_mul_i32 s34, s50, 49152
  s_add_u32 s56, s56, s34
  s_lshl_b32 s69, s50, 1
  s_add_u32 s69, s69, s3
  s_lshl_b32 s34, s69, 9
  s_mul_i32 s35, s40, 49152
  s_add_u32 s34, s34, s35
  s_add_u32 s57, s34, 15728640
  s_lshl_b32 s34, s40, 11
  s_add_u32 s65, s34, 16187392
  s_lshl_b32 s34, s40, 9
  s_add_u32 s62, s34, 8011776
  s_add_u32 s63, s34, 8015872
  s_lshl_b32 s34, s40, 4
  s_add_u32 s35, s34, s52
  s_mul_i32 s59, s35, 13312
  s_add_u32 s59, s59, 4718592
  s_lshl_b32 s35, s69, 1
  s_add_u32 s34, s34, s35
  s_mul_i32 s34, s34, 13312
  s_add_u32 s34, s34, 4718592
  s_mul_i32 s35, s51, 1536
  s_add_u32 s68, s34, s35
  s_lshl_b32 s35, s51, 6
  s_add_u32 s34, s34, s35
  s_add_u32 s58, s34, 12288
  v_lshrrev_b32 v4, 5, v1
  v_and_b32 v6, 31, v1
  v_lshlrev_b32 v8, 4, v6
  v_mul_u32_u24 v7, 24576, v4
  v_add_u32 v8, v8, v7
  s_add_u32 s34, s47, 131072
  v_lshl_add_u32 v12, v6, 2, s34
  v_lshl_add_u32 v13, v3, 2, s34
  v_lshl_add_u32 v14, v2, 4, s34
  v_lshlrev_b32 v74, 2, v6
  v_lshlrev_b32 v7, 4, v3
  v_lshl_add_u32 v15, v4, 8, v7
  v_lshl_add_u32 v15, v5, 3, v15
  v_mul_u32_u24 v9, 13312, v5
  v_lshl_add_u32 v9, v3, 2, v9
  s_lshl_b32 s64, s42, 4
  s_lshl_b32 s34, s41, 2
  s_add_u32 s64, s64, s34
  s_mul_i32 s60, s40, 196608
  s_mul_i32 s35, s52, 12288
  s_add_u32 s66, s60, s35
  s_mul_i32 s34, s53, 6144
  s_add_u32 s66, s66, s34
  s_mul_i32 s34, s41, 1536
  s_add_u32 s66, s66, s34
  s_add_u32 s66, s66, 2359296
  s_add_u32 s61, s60, s35
  s_mul_i32 s35, s53, 384
  s_add_u32 s61, s61, s35
  s_mul_i32 s35, s41, 96
  s_add_u32 s61, s61, s35
  s_mul_i32 s34, s69, 24576
  s_add_u32 s34, s34, s60
  s_mul_i32 s35, s51, 3072
  s_add_u32 s34, s34, s35
  s_add_u32 s67, s34, 6397952
  s_mul_i32 s35, s53, 12288
  s_add_u32 s60, s60, s35
  s_mul_i32 s35, s41, 3072
  s_add_u32 s60, s60, s35
  s_add_u32 s60, s60, 6422528
  s_lshl_b32 s69, s69, 7
  s_add_u32 s69, s69, s65
  s_mul_i32 s20, s41, 12288
  s_add_u32 s20, s20, 81920
  v_mov_b32 v4, v74
  s_barrier
  s_add_u32 m0, s20, 0
  s_nop 0
  buffer_load_dwordx4 v10, s[16:19], s56 offen offset:0 sc1 lds
  buffer_load_dwordx4 v10, s[16:19], s56 offen offset:1024 sc1 lds
  ds_read_b128 v[100:103], v72 offset:0
  ds_read_b128 v[104:107], v72 offset:1024
  ds_read_b128 v[108:111], v72 offset:2048
  buffer_load_dwordx4 v10, s[16:19], s56 offen offset:2048 sc1 lds
  ds_read_b128 v[112:115], v72 offset:3072
  ds_read_b128 v[116:119], v72 offset:4096
  ds_read_b128 v[120:123], v72 offset:5120
  buffer_load_dwordx4 v10, s[16:19], s56 offen offset:3072 sc1 lds
  ds_read_b128 v[124:127], v72 offset:6144
  ds_read_b128 v[128:131], v72 offset:7168
  ds_read_b128 v[132:135], v72 offset:8192
  s_add_u32 m0, s20, 4096
  s_add_u32 s56, s56, 4096
  buffer_load_dwordx4 v10, s[16:19], s56 offen offset:0 sc1 lds
  ds_read_b128 v[136:139], v72 offset:9216
  ds_read_b128 v[140:143], v72 offset:10240
  ds_read_b128 v[144:147], v72 offset:11264
  buffer_load_dwordx4 v10, s[16:19], s56 offen offset:1024 sc1 lds
  ds_read_b128 v[148:151], v72 offset:12288
  ds_read_b128 v[152:155], v72 offset:13312
  ds_read_b128 v[156:159], v72 offset:14336
  buffer_load_dwordx4 v10, s[16:19], s56 offen offset:2048 sc1 lds
  ds_read_b128 v[160:163], v72 offset:15360
  ds_read_b128 v[164:167], v72 offset:16384
  ds_read_b128 v[168:171], v72 offset:17408
  buffer_load_dwordx4 v10, s[16:19], s56 offen offset:3072 sc1 lds
  ds_read_b128 v[172:175], v72 offset:18432
  ds_read_b128 v[176:179], v72 offset:19456
  ds_read_b128 v[180:183], v72 offset:20480
  buffer_load_dwordx4 v[32:35], v8, s[16:19], s57 offen sc1
  ds_read_b128 v[184:187], v72 offset:21504
  ds_read_b128 v[188:191], v72 offset:22528
  ds_read_b128 v[192:195], v72 offset:23552
  s_add_u32 s57, s57, 4096
  buffer_load_dwordx4 v[36:39], v8, s[16:19], s57 offen sc1
  ds_read_b128 v[196:199], v72 offset:24576
  ds_read_b128 v[200:203], v72 offset:25600
  ds_read_b128 v[204:207], v72 offset:26624
  s_add_u32 s57, s57, 4096
  buffer_load_dwordx4 v[40:43], v8, s[16:19], s57 offen sc1
  ds_read_b128 v[208:211], v72 offset:27648
  ds_read_b128 v[212:215], v72 offset:28672
  ds_read_b128 v[216:219], v72 offset:29696
  s_add_u32 s57, s57, 4096
  buffer_load_dwordx4 v[44:47], v8, s[16:19], s57 offen sc1
  ds_read_b128 v[220:223], v72 offset:30720
  ds_read_b128 v[224:227], v72 offset:31744
  ds_read_b128 v[228:231], v72 offset:32768
  s_add_u32 s57, s57, 4096
  buffer_load_dwordx4 v[48:51], v8, s[16:19], s57 offen sc1
  ds_read_b128 v[232:235], v72 offset:33792
  ds_read_b128 v[236:239], v72 offset:34816
  ds_read_b128 v[240:243], v72 offset:35840
  s_add_u32 s57, s57, 4096
  buffer_load_dwordx4 v[52:55], v8, s[16:19], s57 offen sc1
  ds_read2_b32 v[244:245], v73 offset0:0 offset1:48
  ds_read2_b32 v[246:247], v73 offset0:96 offset1:144
  ds_read2_b32 v[248:249], v73 offset0:16 offset1:64
  ds_read2_b32 v[250:251], v73 offset0:112 offset1:160
  ds_read2_b32 v[252:253], v73 offset0:32 offset1:80
  ds_read2_b32 v[254:255], v73 offset0:128 offset1:176
  s_add_u32 m0, s20, 8192
  s_add_u32 s56, s56, 4096
  buffer_load_dwordx4 v10, s[16:19], s56 offen offset:0 sc1 lds
  buffer_load_dwordx4 v10, s[16:19], s56 offen offset:1024 sc1 lds
  buffer_load_dwordx4 v10, s[16:19], s56 offen offset:2048 sc1 lds
  buffer_load_dwordx4 v10, s[16:19], s56 offen offset:3072 sc1 lds
  s_cmp_ge_u32 s51, 8
  s_cbranch_scc1 P2_v
  s_waitcnt vmcnt(14)
  s_barrier
  ds_read_b128 v[56:59], v11 offset:0
  ds_read_b128 v[60:63], v11 offset:12288
  s_waitcnt lgkmcnt(0)
  v_mfma_f32_16x16x32_bf16 v[76:79], v[100:103], v[56:59], 0
  v_mfma_f32_16x16x32_bf16 v[88:91], v[100:103], v[60:63], 0
  ds_read_b128 v[64:67], v11 offset:1024
  ds_read_b128 v[68:71], v11 offset:13312
  v_mfma_f32_16x16x32_bf16 v[80:83], v[104:107], v[56:59], 0
  v_mfma_f32_16x16x32_bf16 v[92:95], v[104:107], v[60:63], 0
  v_mfma_f32_16x16x32_bf16 v[84:87], v[108:111], v[56:59], 0
  v_mfma_f32_16x16x32_bf16 v[96:99], v[108:111], v[60:63], 0
  s_waitcnt lgkmcnt(0)
  v_mfma_f32_16x16x32_bf16 v[76:79], v[112:115], v[64:67], v[76:79]
  v_mfma_f32_16x16x32_bf16 v[88:91], v[112:115], v[68:71], v[88:91]
  ds_read_b128 v[56:59], v11 offset:2048
  ds_read_b128 v[60:63], v11 offset:14336
  v_mfma_f32_16x16x32_bf16 v[80:83], v[116:119], v[64:67], v[80:83]
  v_mfma_f32_16x16x32_bf16 v[92:95], v[116:119], v[68:71], v[92:95]
  v_mfma_f32_16x16x32_bf16 v[84:87], v[120:123], v[64:67], v[84:87]
  v_mfma_f32_16x16x32_bf16 v[96:99], v[120:123], v[68:71], v[96:99]
  s_waitcnt lgkmcnt(0)
  v_mfma_f32_16x16x32_bf16 v[76:79], v[124:127], v[56:59], v[76:79]
  v_mfma_f32_16x16x32_bf16 v[88:91], v[124:127], v[60:63], v[88:91]
  ds_read_b128 v[64:67], v11 offset:3072
  ds_read_b128 v[68:71], v11 offset:15360
  v_mfma_f32_16x16x32_bf16 v[80:83], v[128:131], v[56:59], v[80:83]
  v_mfma_f32_16x16x32_bf16 v[92:95], v[128:131], v[60:63], v[92:95]
  v_mfma_f32_16x16x32_bf16 v[84:87], v[132:135], v[56:59], v[84:87]
  v_mfma_f32_16x16x32_bf16 v[96:99], v[132:135], v[60:63], v[96:99]
  s_waitcnt vmcnt(10)
  s_barrier
  s_waitcnt lgkmcnt(0)
  v_mfma_f32_16x16x32_bf16 v[76:79], v[136:139], v[64:67], v[76:79]
  v_mfma_f32_16x16x32_bf16 v[88:91], v[136:139], v[68:71], v[88:91]
  ds_read_b128 v[56:59], v11 offset:4096
  ds_read_b128 v[60:63], v11 offset:16384
  v_mfma_f32_16x16x32_bf16 v[80:83], v[140:143], v[64:67], v[80:83]
  v_mfma_f32_16x16x32_bf16 v[92:95], v[140:143], v[68:71], v[92:95]
  v_mfma_f32_16x16x32_bf16 v[84:87], v[144:147], v[64:67], v[84:87]
  v_mfma_f32_16x16x32_bf16 v[96:99], v[144:147], v[68:71], v[96:99]
  s_waitcnt lgkmcnt(0)
  v_mfma_f32_16x16x32_bf16 v[76:79], v[148:151], v[56:59], v[76:79]
  v_mfma_f32_16x16x32_bf16 v[88:91], v[148:151], v[60:63], v[88:91]
  ds_read_b128 v[64:67], v11 offset:5120
  ds_read_b128 v[68:71], v11 offset:17408
  v_mfma_f32_16x16x32_bf16 v[80:83], v[152:155], v[56:59], v[80:83]
  v_mfma_f32_16x16x32_bf16 v[92:95], v[152:155], v[60:63], v[92:95]
  v_mfma_f32_16x16x32_bf16 v[84:87], v[156:159], v[56:59], v[84:87]
  v_mfma_f32_16x16x32_bf16 v[96:99], v[156:159], v[60:63], v[96:99]
  s_waitcnt lgkmcnt(0)
  v_mfma_f32_16x16x32_bf16 v[76:79], v[160:163], v[64:67], v[76:79]
  s_mov_b32 s36, 0x3b2aaaab
  s_mov_b32 s37, 0x3727c5ac
  v_mfma_f32_16x16x32_bf16 v[88:91], v[160:163], v[68:71], v[88:91]
  s_waitcnt vmcnt(4)
  v_add_f32 v32, v32, v36
  ds_read_b128 v[56:59], v11 offset:6144
  ds_read_b128 v[60:63], v11 offset:18432
  v_mfma_f32_16x16x32_bf16 v[80:83], v[164:167], v[64:67], v[80:83]
  v_add_f32 v40, v40, v44
  v_add_f32 v48, v48, v52
  v_mfma_f32_16x16x32_bf16 v[92:95], v[164:167], v[68:71], v[92:95]
  v_add_f32 v33, v33, v37
  v_add_f32 v41, v41, v45
  v_mfma_f32_16x16x32_bf16 v[84:87], v[168:171], v[64:67], v[84:87]
  v_add_f32 v49, v49, v53
  v_add_f32 v32, v32, v40
  v_mfma_f32_16x16x32_bf16 v[96:99], v[168:171], v[68:71], v[96:99]
  v_add_f32 v33, v33, v41
  v_add_f32 v32, v32, v48
  s_waitcnt lgkmcnt(0)
  v_mfma_f32_16x16x32_bf16 v[76:79], v[172:175], v[56:59], v[76:79]
  v_add_f32 v33, v33, v49
  v_mov_b32 v34, v32
  v_mfma_f32_16x16x32_bf16 v[88:91], v[172:175], v[60:63], v[88:91]
  v_mov_b32 v35, v33
  v_cmp_eq_u32 vcc, 3, v2
  ds_read_b128 v[64:67], v11 offset:7168
  ds_read_b128 v[68:71], v11 offset:19456
  v_mfma_f32_16x16x32_bf16 v[80:83], v[176:179], v[56:59], v[80:83]
  v_permlane32_swap_b32 v32, v34
  v_permlane32_swap_b32 v33, v35
  v_mfma_f32_16x16x32_bf16 v[92:95], v[176:179], v[60:63], v[92:95]
  v_add_f32 v32, v32, v34
  v_add_f32 v33, v33, v35
  v_mfma_f32_16x16x32_bf16 v[84:87], v[180:183], v[56:59], v[84:87]
  v_mul_f32 v32, s36, v32
  v_mul_f32 v34, v32, v32
  v_mfma_f32_16x16x32_bf16 v[96:99], v[180:183], v[60:63], v[96:99]
  v_fma_f32 v33, v33, s36, -v34
  v_max_f32 v33, 0, v33
  s_waitcnt vmcnt(0)
  s_barrier
  s_waitcnt lgkmcnt(0)
  v_mfma_f32_16x16x32_bf16 v[76:79], v[184:187], v[64:67], v[76:79]
  v_add_f32 v33, s37, v33
  v_rsq_f32 v33, v33
  v_mfma_f32_16x16x32_bf16 v[88:91], v[184:187], v[68:71], v[88:91]
  v_cvt_pk_bf16_f32 v32, -v32, -v32
  ds_write_b32 v12, v32
  ds_read_b128 v[56:59], v11 offset:8192
  ds_read_b128 v[60:63], v11 offset:20480
  v_mfma_f32_16x16x32_bf16 v[80:83], v[188:191], v[64:67], v[80:83]
  ds_write_b32 v12, v33 offset:128
  ds_read2_b32 v[36:37], v13 offset0:0 offset1:16
  v_mfma_f32_16x16x32_bf16 v[92:95], v[188:191], v[68:71], v[92:95]
  ds_read2_b32 v[6:7], v13 offset0:32 offset1:48
  ds_read_b128 v[16:19], v14 offset:128
  v_mfma_f32_16x16x32_bf16 v[84:87], v[192:195], v[64:67], v[84:87]
  ds_read_b128 v[20:23], v14 offset:192
  v_mfma_f32_16x16x32_bf16 v[96:99], v[192:195], v[68:71], v[96:99]
  s_waitcnt lgkmcnt(5)
  v_mfma_f32_16x16x32_bf16 v[76:79], v[196:199], v[56:59], v[76:79]
  s_waitcnt lgkmcnt(0)
  v_cndmask_b32 v24, v36, 0, vcc
  v_mfma_f32_16x16x32_bf16 v[88:91], v[196:199], v[60:63], v[88:91]
  v_mov_b32 v25, v24
  v_mov_b32 v26, v24
  ds_read_b128 v[64:67], v11 offset:9216
  ds_read_b128 v[68:71], v11 offset:21504
  v_mfma_f32_16x16x32_bf16 v[80:83], v[200:203], v[56:59], v[80:83]
  v_mov_b32 v27, v24
  v_cndmask_b32 v28, v37, 0, vcc
  v_mfma_f32_16x16x32_bf16 v[92:95], v[200:203], v[60:63], v[92:95]
  v_mov_b32 v29, v28
  v_mov_b32 v30, v28
  v_mfma_f32_16x16x32_bf16 v[84:87], v[204:207], v[56:59], v[84:87]
  v_mov_b32 v31, v28
  v_mov_b32 v72, 0x3f803f80
  v_mfma_f32_16x16x32_bf16 v[96:99], v[204:207], v[60:63], v[96:99]
  v_mov_b32 v73, 0x3f803f80
  v_mov_b32 v74, 0x3f803f80
  s_waitcnt lgkmcnt(0)
  v_mfma_f32_16x16x32_bf16 v[76:79], v[208:211], v[64:67], v[76:79]
  v_mov_b32 v75, 0x3f803f80
  v_mul_f32 v6, 0x3d96c740, v6
  v_mfma_f32_16x16x32_bf16 v[88:91], v[208:211], v[68:71], v[88:91]
  v_mul_f32 v7, 0x3d96c740, v7
  ds_read_b128 v[56:59], v11 offset:10240
  ds_read_b128 v[60:63], v11 offset:22528
  v_mfma_f32_16x16x32_bf16 v[80:83], v[212:215], v[64:67], v[80:83]
  v_mfma_f32_16x16x32_bf16 v[92:95], v[212:215], v[68:71], v[92:95]
  v_mfma_f32_16x16x32_bf16 v[84:87], v[216:219], v[64:67], v[84:87]
  v_mfma_f32_16x16x32_bf16 v[96:99], v[216:219], v[68:71], v[96:99]
  s_waitcnt lgkmcnt(0)
  v_mfma_f32_16x16x32_bf16 v[76:79], v[220:223], v[56:59], v[76:79]
  v_mfma_f32_16x16x32_bf16 v[88:91], v[220:223], v[60:63], v[88:91]
  ds_read_b128 v[64:67], v11 offset:11264
  ds_read_b128 v[68:71], v11 offset:23552
  v_mfma_f32_16x16x32_bf16 v[80:83], v[224:227], v[56:59], v[80:83]
  v_mfma_f32_16x16x32_bf16 v[92:95], v[224:227], v[60:63], v[92:95]
  v_mfma_f32_16x16x32_bf16 v[84:87], v[228:231], v[56:59], v[84:87]
  v_mfma_f32_16x16x32_bf16 v[96:99], v[228:231], v[60:63], v[96:99]
  s_waitcnt lgkmcnt(0)
  v_mfma_f32_16x16x32_bf16 v[76:79], v[232:235], v[64:67], v[76:79]
  v_mfma_f32_16x16x32_bf16 v[88:91], v[232:235], v[68:71], v[88:91]
  v_mfma_f32_16x16x32_bf16 v[80:83], v[236:239], v[64:67], v[80:83]
  v_mfma_f32_16x16x32_bf16 v[92:95], v[236:239], v[68:71], v[92:95]
  v_mfma_f32_16x16x32_bf16 v[84:87], v[240:243], v[64:67], v[84:87]
  v_mfma_f32_16x16x32_bf16 v[96:99], v[240:243], v[68:71], v[96:99]
  v_mfma_f32_16x16x32_bf16 v[76:79], v[244:247], v[24:27], v[76:79]
  v_mfma_f32_16x16x32_bf16 v[88:91], v[244:247], v[28:31], v[88:91]
  v_mfma_f32_16x16x32_bf16 v[80:83], v[248:251], v[24:27], v[80:83]
  v_mfma_f32_16x16x32_bf16 v[92:95], v[248:251], v[28:31], v[92:95]
  v_mfma_f32_16x16x32_bf16 v[84:87], v[252:255], v[24:27], v[84:87]
  v_mfma_f32_16x16x32_bf16 v[96:99], v[252:255], v[28:31], v[96:99]
  s_cmp_lg_u32 s51, 0
  s_cbranch_scc1 fs_14
  s_mov_b32 exec_hi, 0
  buffer_store_dword v32, v4, s[16:19], s69 offen sc1
  buffer_store_dword v33, v4, s[16:19], s69 offen offset:1024 sc1
  s_mov_b32 exec_hi, -1
fs_14:
  s_nop 0
  v_pk_mul_f32 v[76:77], v[76:77], v[6:7] op_sel:[0,0] op_sel_hi:[1,0]
  v_pk_mul_f32 v[78:79], v[78:79], v[6:7] op_sel:[0,0] op_sel_hi:[1,0]
  v_cvt_pk_bf16_f32 v100, v76, v77
  v_cvt_pk_bf16_f32 v101, v78, v79
  v_pk_mul_f32 v[80:81], v[80:81], v[6:7] op_sel:[0,0] op_sel_hi:[1,0]
  v_pk_mul_f32 v[82:83], v[82:83], v[6:7] op_sel:[0,0] op_sel_hi:[1,0]
  v_cvt_pk_bf16_f32 v102, v80, v81
  v_cvt_pk_bf16_f32 v103, v82, v83
  v_pk_mul_f32 v[84:85], v[84:85], v[6:7] op_sel:[0,0] op_sel_hi:[1,0]
  v_pk_mul_f32 v[86:87], v[86:87], v[6:7] op_sel:[0,0] op_sel_hi:[1,0]
  v_cvt_pk_bf16_f32 v104, v84, v85
  v_cvt_pk_bf16_f32 v105, v86, v87
  v_pk_mul_f32 v[88:89], v[88:89], v[6:7] op_sel:[0,1] op_sel_hi:[1,1]
  v_pk_mul_f32 v[90:91], v[90:91], v[6:7] op_sel:[0,1] op_sel_hi:[1,1]
  v_cvt_pk_bf16_f32 v106, v88, v89
  v_cvt_pk_bf16_f32 v107, v90, v91
  v_pk_mul_f32 v[92:93], v[92:93], v[6:7] op_sel:[0,1] op_sel_hi:[1,1]
  v_pk_mul_f32 v[94:95], v[94:95], v[6:7] op_sel:[0,1] op_sel_hi:[1,1]
  v_cvt_pk_bf16_f32 v108, v92, v93
  v_cvt_pk_bf16_f32 v109, v94, v95
  v_pk_mul_f32 v[96:97], v[96:97], v[6:7] op_sel:[0,1] op_sel_hi:[1,1]
  v_pk_mul_f32 v[98:99], v[98:99], v[6:7] op_sel:[0,1] op_sel_hi:[1,1]
  v_cvt_pk_bf16_f32 v110, v96, v97
  v_cvt_pk_bf16_f32 v111, v98, v99
  v_mfma_f32_16x16x32_bf16 v[76:79], v[72:75], v[100:103], 0
  v_mfma_f32_16x16x32_bf16 v[80:83], v[72:75], v[106:109], 0
  buffer_store_dwordx2 v[100:101], v15, s[16:19], s68 offen offset:0 sc1
  buffer_store_dwordx2 v[102:103], v15, s[16:19], s68 offen offset:512 sc1
  buffer_store_dwordx2 v[104:105], v15, s[16:19], s68 offen offset:1024 sc1
  s_add_u32 s68, s68, 13312
  s_nop 1
  v_mfma_f32_16x16x16_bf16 v[84:87], v[72:73], v[104:105], v[76:79]
  v_mfma_f32_16x16x16_bf16 v[88:91], v[72:73], v[110:111], v[80:83]
  buffer_store_dwordx2 v[106:107], v15, s[16:19], s68 offen offset:0 sc1
  buffer_store_dwordx2 v[108:109], v15, s[16:19], s68 offen offset:512 sc1
  buffer_store_dwordx2 v[110:111], v15, s[16:19], s68 offen offset:1024 sc1
  v_cmp_eq_u32 vcc, 1, v5
  s_nop 3
  v_cndmask_b32 v112, v84, v88, vcc
  v_cvt_pk_bf16_f32 v113, v112, v112
  v_lshlrev_b32 v113, 16, v113
  v_sub_f32 v113, v112, v113
  v_cvt_pk_bf16_f32 v112, v112, v113
  s_mov_b32 exec_hi, 0
  buffer_store_dword v112, v9, s[16:19], s58 offen sc1
  s_mov_b32 exec_hi, -1
  s_branch P2_j
P2_v:
  s_waitcnt vmcnt(14)
  s_barrier
  ds_read_b128 v[56:59], v11 offset:0
  ds_read_b128 v[60:63], v11 offset:12288
  s_waitcnt lgkmcnt(0)
  v_mfma_f32_16x16x32_bf16 v[76:79], v[56:59], v[100:103], 0
  v_mfma_f32_16x16x32_bf16 v[88:91], v[60:63], v[100:103], 0
  ds_read_b128 v[64:67], v11 offset:1024
  ds_read_b128 v[68:71], v11 offset:13312
  v_mfma_f32_16x16x32_bf16 v[80:83], v[56:59], v[104:107], 0
  v_mfma_f32_16x16x32_bf16 v[92:95], v[60:63], v[104:107], 0
  v_mfma_f32_16x16x32_bf16 v[84:87], v[56:59], v[108:111], 0
  v_mfma_f32_16x16x32_bf16 v[96:99], v[60:63], v[108:111], 0
  s_waitcnt lgkmcnt(0)
  v_mfma_f32_16x16x32_bf16 v[76:79], v[64:67], v[112:115], v[76:79]
  v_mfma_f32_16x16x32_bf16 v[88:91], v[68:71], v[112:115], v[88:91]
  ds_read_b128 v[56:59], v11 offset:2048
  ds_read_b128 v[60:63], v11 offset:14336
  v_mfma_f32_16x16x32_bf16 v[80:83], v[64:67], v[116:119], v[80:83]
  v_mfma_f32_16x16x32_bf16 v[92:95], v[68:71], v[116:119], v[92:95]
  v_mfma_f32_16x16x32_bf16 v[84:87], v[64:67], v[120:123], v[84:87]
  v_mfma_f32_16x16x32_bf16 v[96:99], v[68:71], v[120:123], v[96:99]
  s_waitcnt lgkmcnt(0)
  v_mfma_f32_16x16x32_bf16 v[76:79], v[56:59], v[124:127], v[76:79]
  v_mfma_f32_16x16x32_bf16 v[88:91], v[60:63], v[124:127], v[88:91]
  ds_read_b128 v[64:67], v11 offset:3072
  ds_read_b128 v[68:71], v11 offset:15360
  v_mfma_f32_16x16x32_bf16 v[80:83], v[56:59], v[128:131], v[80:83]
  v_mfma_f32_16x16x32_bf16 v[92:95], v[60:63], v[128:131], v[92:95]
  v_mfma_f32_16x16x32_bf16 v[84:87], v[56:59], v[132:135], v[84:87]
  v_mfma_f32_16x16x32_bf16 v[96:99], v[60:63], v[132:135], v[96:99]
  s_waitcnt vmcnt(10)
  s_barrier
  s_waitcnt lgkmcnt(0)
  v_mfma_f32_16x16x32_bf16 v[76:79], v[64:67], v[136:139], v[76:79]
  v_mfma_f32_16x16x32_bf16 v[88:91], v[68:71], v[136:139], v[88:91]
  ds_read_b128 v[56:59], v11 offset:4096
  ds_read_b128 v[60:63], v11 offset:16384
  v_mfma_f32_16x16x32_bf16 v[80:83], v[64:67], v[140:143], v[80:83]
  v_mfma_f32_16x16x32_bf16 v[92:95], v[68:71], v[140:143], v[92:95]
  v_mfma_f32_16x16x32_bf16 v[84:87], v[64:67], v[144:147], v[84:87]
  v_mfma_f32_16x16x32_bf16 v[96:99], v[68:71], v[144:147], v[96:99]
  s_waitcnt lgkmcnt(0)
  v_mfma_f32_16x16x32_bf16 v[76:79], v[56:59], v[148:151], v[76:79]
  v_mfma_f32_16x16x32_bf16 v[88:91], v[60:63], v[148:151], v[88:91]
  ds_read_b128 v[64:67], v11 offset:5120
  ds_read_b128 v[68:71], v11 offset:17408
  v_mfma_f32_16x16x32_bf16 v[80:83], v[56:59], v[152:155], v[80:83]
  v_mfma_f32_16x16x32_bf16 v[92:95], v[60:63], v[152:155], v[92:95]
  v_mfma_f32_16x16x32_bf16 v[84:87], v[56:59], v[156:159], v[84:87]
  v_mfma_f32_16x16x32_bf16 v[96:99], v[60:63], v[156:159], v[96:99]
  s_waitcnt lgkmcnt(0)
  v_mfma_f32_16x16x32_bf16 v[76:79], v[64:67], v[160:163], v[76:79]
  s_mov_b32 s36, 0x3b2aaaab
  s_mov_b32 s37, 0x3727c5ac
  v_mfma_f32_16x16x32_bf16 v[88:91], v[68:71], v[160:163], v[88:91]
  s_waitcnt vmcnt(4)
  v_add_f32 v32, v32, v36
  ds_read_b128 v[56:59], v11 offset:6144
  ds_read_b128 v[60:63], v11 offset:18432
  v_mfma_f32_16x16x32_bf16 v[80:83], v[64:67], v[164:167], v[80:83]
  v_add_f32 v40, v40, v44
  v_add_f32 v48, v48, v52
  v_mfma_f32_16x16x32_bf16 v[92:95], v[68:71], v[164:167], v[92:95]
  v_add_f32 v33, v33, v37
  v_add_f32 v41, v41, v45
  v_mfma_f32_16x16x32_bf16 v[84:87], v[64:67], v[168:171], v[84:87]
  v_add_f32 v49, v49, v53
  v_add_f32 v32, v32, v40
  v_mfma_f32_16x16x32_bf16 v[96:99], v[68:71], v[168:171], v[96:99]
  v_add_f32 v33, v33, v41
  v_add_f32 v32, v32, v48
  s_waitcnt lgkmcnt(0)
  v_mfma_f32_16x16x32_bf16 v[76:79], v[56:59], v[172:175], v[76:79]
  v_add_f32 v33, v33, v49
  v_mov_b32 v34, v32
  v_mfma_f32_16x16x32_bf16 v[88:91], v[60:63], v[172:175], v[88:91]
  v_mov_b32 v35, v33
  v_cmp_eq_u32 vcc, 3, v2
  ds_read_b128 v[64:67], v11 offset:7168
  ds_read_b128 v[68:71], v11 offset:19456
  v_mfma_f32_16x16x32_bf16 v[80:83], v[56:59], v[176:179], v[80:83]
  v_permlane32_swap_b32 v32, v34
  v_permlane32_swap_b32 v33, v35
  v_mfma_f32_16x16x32_bf16 v[92:95], v[60:63], v[176:179], v[92:95]
  v_add_f32 v32, v32, v34
  v_add_f32 v33, v33, v35
  v_mfma_f32_16x16x32_bf16 v[84:87], v[56:59], v[180:183], v[84:87]
  v_mul_f32 v32, s36, v32
  v_mul_f32 v34, v32, v32
  v_mfma_f32_16x16x32_bf16 v[96:99], v[60:63], v[180:183], v[96:99]
  v_fma_f32 v33, v33, s36, -v34
  v_max_f32 v33, 0, v33
  s_waitcnt vmcnt(0)
  s_barrier
  s_waitcnt lgkmcnt(0)
  v_mfma_f32_16x16x32_bf16 v[76:79], v[64:67], v[184:187], v[76:79]
  v_add_f32 v33, s37, v33
  v_rsq_f32 v33, v33
  v_mfma_f32_16x16x32_bf16 v[88:91], v[68:71], v[184:187], v[88:91]
  v_cvt_pk_bf16_f32 v32, -v32, -v32
  ds_write_b32 v12, v32
  ds_read_b128 v[56:59], v11 offset:8192
  ds_read_b128 v[60:63], v11 offset:20480
  v_mfma_f32_16x16x32_bf16 v[80:83], v[64:67], v[188:191], v[80:83]
  ds_write_b32 v12, v33 offset:128
  ds_read2_b32 v[36:37], v13 offset0:0 offset1:16
  v_mfma_f32_16x16x32_bf16 v[92:95], v[68:71], v[188:191], v[92:95]
  ds_read2_b32 v[6:7], v13 offset0:32 offset1:48
  ds_read_b128 v[16:19], v14 offset:128
  v_mfma_f32_16x16x32_bf16 v[84:87], v[64:67], v[192:195], v[84:87]
  ds_read_b128 v[20:23], v14 offset:192
  v_mfma_f32_16x16x32_bf16 v[96:99], v[68:71], v[192:195], v[96:99]
  s_waitcnt lgkmcnt(5)
  v_mfma_f32_16x16x32_bf16 v[76:79], v[56:59], v[196:199], v[76:79]
  s_waitcnt lgkmcnt(0)
  v_cndmask_b32 v24, v36, 0, vcc
  v_mfma_f32_16x16x32_bf16 v[88:91], v[60:63], v[196:199], v[88:91]
  v_mov_b32 v25, v24
  v_mov_b32 v26, v24
  ds_read_b128 v[64:67], v11 offset:9216
  ds_read_b128 v[68:71], v11 offset:21504
  v_mfma_f32_16x16x32_bf16 v[80:83], v[56:59], v[200:203], v[80:83]
  v_mov_b32 v27, v24
  v_cndmask_b32 v28, v37, 0, vcc
  v_mfma_f32_16x16x32_bf16 v[92:95], v[60:63], v[200:203], v[92:95]
  v_mov_b32 v29, v28
  v_mov_b32 v30, v28
  v_mfma_f32_16x16x32_bf16 v[84:87], v[56:59], v[204:207], v[84:87]
  v_mov_b32 v31, v28
  v_mov_b32 v72, 0x3f803f80
  v_mfma_f32_16x16x32_bf16 v[96:99], v[60:63], v[204:207], v[96:99]
  v_mov_b32 v73, 0x3f803f80
  v_mov_b32 v74, 0x3f803f80
  s_waitcnt lgkmcnt(0)
  v_mfma_f32_16x16x32_bf16 v[76:79], v[64:67], v[208:211], v[76:79]
  v_mov_b32 v75, 0x3f803f80
  v_mul_f32 v6, 0x3d96c740, v6
  v_mfma_f32_16x16x32_bf16 v[88:91], v[68:71], v[208:211], v[88:91]
  v_mul_f32 v7, 0x3d96c740, v7
  ds_read_b128 v[56:59], v11 offset:10240
  ds_read_b128 v[60:63], v11 offset:22528
  v_mfma_f32_16x16x32_bf16 v[80:83], v[64:67], v[212:215], v[80:83]
  v_mfma_f32_16x16x32_bf16 v[92:95], v[68:71], v[212:215], v[92:95]
  v_mfma_f32_16x16x32_bf16 v[84:87], v[64:67], v[216:219], v[84:87]
  v_mfma_f32_16x16x32_bf16 v[96:99], v[68:71], v[216:219], v[96:99]
  s_waitcnt lgkmcnt(0)
  v_mfma_f32_16x16x32_bf16 v[76:79], v[56:59], v[220:223], v[76:79]
  v_mfma_f32_16x16x32_bf16 v[88:91], v[60:63], v[220:223], v[88:91]
  ds_read_b128 v[64:67], v11 offset:11264
  ds_read_b128 v[68:71], v11 offset:23552
  v_mfma_f32_16x16x32_bf16 v[80:83], v[56:59], v[224:227], v[80:83]
  v_mfma_f32_16x16x32_bf16 v[92:95], v[60:63], v[224:227], v[92:95]
  v_mfma_f32_16x16x32_bf16 v[84:87], v[56:59], v[228:231], v[84:87]
  v_mfma_f32_16x16x32_bf16 v[96:99], v[60:63], v[228:231], v[96:99]
  s_waitcnt lgkmcnt(0)
  v_mfma_f32_16x16x32_bf16 v[76:79], v[64:67], v[232:235], v[76:79]
  v_mfma_f32_16x16x32_bf16 v[88:91], v[68:71], v[232:235], v[88:91]
  v_mfma_f32_16x16x32_bf16 v[80:83], v[64:67], v[236:239], v[80:83]
  v_mfma_f32_16x16x32_bf16 v[92:95], v[68:71], v[236:239], v[92:95]
  v_mfma_f32_16x16x32_bf16 v[84:87], v[64:67], v[240:243], v[84:87]
  v_mfma_f32_16x16x32_bf16 v[96:99], v[68:71], v[240:243], v[96:99]
  v_mfma_f32_16x16x32_bf16 v[76:79], v[24:27], v[244:247], v[76:79]
  v_mfma_f32_16x16x32_bf16 v[88:91], v[28:31], v[244:247], v[88:91]
  v_mfma_f32_16x16x32_bf16 v[80:83], v[24:27], v[248:251], v[80:83]
  v_mfma_f32_16x16x32_bf16 v[92:95], v[28:31], v[248:251], v[92:95]
  v_mfma_f32_16x16x32_bf16 v[84:87], v[24:27], v[252:255], v[84:87]
  v_mfma_f32_16x16x32_bf16 v[96:99], v[28:31], v[252:255], v[96:99]
  s_nop 2
  v_pk_mul_f32 v[76:77], v[76:77], v[16:17]
  v_pk_mul_f32 v[78:79], v[78:79], v[18:19]
  v_cvt_pk_bf16_f32 v100, v76, v77
  v_cvt_pk_bf16_f32 v101, v78, v79
  v_pk_mul_f32 v[88:89], v[88:89], v[20:21]
  v_pk_mul_f32 v[90:91], v[90:91], v[22:23]
  v_cvt_pk_bf16_f32 v102, v88, v89
  v_cvt_pk_bf16_f32 v103, v90, v91
  buffer_store_dwordx4 v[100:103], v10, s[16:19], s67 offen offset:0 sc1
  v_pk_mul_f32 v[80:81], v[80:81], v[16:17]
  v_pk_mul_f32 v[82:83], v[82:83], v[18:19]
  v_cvt_pk_bf16_f32 v104, v80, v81
  v_cvt_pk_bf16_f32 v105, v82, v83
  v_pk_mul_f32 v[92:93], v[92:93], v[20:21]
  v_pk_mul_f32 v[94:95], v[94:95], v[22:23]
  v_cvt_pk_bf16_f32 v106, v92, v93
  v_cvt_pk_bf16_f32 v107, v94, v95
  buffer_store_dwordx4 v[104:107], v10, s[16:19], s67 offen offset:1024 sc1
  v_pk_mul_f32 v[84:85], v[84:85], v[16:17]
  v_pk_mul_f32 v[86:87], v[86:87], v[18:19]
  v_cvt_pk_bf16_f32 v108, v84, v85
  v_cvt_pk_bf16_f32 v109, v86, v87
  v_pk_mul_f32 v[96:97], v[96:97], v[20:21]
  v_pk_mul_f32 v[98:99], v[98:99], v[22:23]
  v_cvt_pk_bf16_f32 v110, v96, v97
  v_cvt_pk_bf16_f32 v111, v98, v99
  buffer_store_dwordx4 v[108:111], v10, s[16:19], s67 offen offset:2048 sc1
P2_j:
  v_add_u32 v6, s20, v10
  ds_read_b128 v[208:211], v6 offset:0
  ds_read_b128 v[212:215], v6 offset:1024
  ds_read_b128 v[216:219], v6 offset:2048
  ds_read_b128 v[220:223], v6 offset:3072
  ds_read_b128 v[224:227], v6 offset:4096
  ds_read_b128 v[228:231], v6 offset:5120
  ds_read_b128 v[232:235], v6 offset:6144
  ds_read_b128 v[236:239], v6 offset:7168
  ds_read_b128 v[240:243], v6 offset:8192
  ds_read_b128 v[244:247], v6 offset:9216
  ds_read_b128 v[248:251], v6 offset:10240
  ds_read_b128 v[252:255], v6 offset:11264
  s_lshl_b32 s34, s3, 10
  s_and_b32 s35, s41, 1
  s_lshl_b32 s35, s35, 3
  s_add_u32 s34, s34, s35
  s_add_u32 s34, s34, 16384
  v_add_u32 v13, s34, v10
  s_lshl_b32 s34, s41, 2
  s_add_u32 s34, s34, 24576
  v_lshl_add_u32 v14, v3, 5, s34
  v_lshlrev_b32 v12, 5, v3
  v_add_u32 v12, 24576, v12
  v_lshlrev_b32 v11, 2, v3
  v_lshl_add_u32 v11, v5, 8, v11
  v_add_u32 v11, 12288, v11
  s_lshl_b32 s34, s50, 2
  s_add_u32 s34, s34, s41
  s_lshl_b32 s34, s34, 6
  s_add_u32 s34, s34, 13312
  v_lshl_add_u32 v54, v3, 2, s34
  s_add_u32 s34, s34, 1024
  v_lshl_add_u32 v55, v2, 4, s34
  s_lshl_b32 s34, s50, 11
  v_add_u32 v13, s34, v13
  s_waitcnt vmcnt(0) lgkmcnt(0)
  s_mov_b64 exec, 1
  v_mov_b32 v6, s64
  v_mov_b32 v7, s45
  buffer_store_dword v7, v6, s[16:19], s62 offen
  s_mov_b64 exec, -1
  buffer_load_dwordx2 v[48:49], v15, s[16:19], s66 offen offset:0 sc1
  buffer_load_dwordx2 v[50:51], v15, s[16:19], s66 offen offset:512 sc1
  buffer_load_dwordx2 v[52:53], v15, s[16:19], s66 offen offset:1024 sc1
  s_lshl_b32 s35, s41, 11
  s_add_u32 s35, s35, 26624
  v_mul_u32_u24 v8, 112, v3
  v_lshl_add_u32 v8, v2, 3, v8
  v_add_u32 v8, s35, v8
  v_add_u32 v56, 0, v1
  v_mul_u32_u24 v57, 43, v56
  v_lshrrev_b32 v57, 8, v57
  v_mul_u32_u24 v58, 6, v57
  v_sub_u32 v58, v56, v58
  v_lshlrev_b32 v58, 4, v58
  v_mul_u32_u24 v56, 112, v57
  v_add3_u32 v60, v56, v58, s35
  v_mul_u32_u24 v56, 768, v57
  v_add_u32 v6, v56, v58
  v_add_u32 v56, 64, v1
  v_mul_u32_u24 v57, 43, v56
  v_lshrrev_b32 v57, 8, v57
  v_mul_u32_u24 v58, 6, v57
  v_sub_u32 v58, v56, v58
  v_lshlrev_b32 v58, 4, v58
  v_mul_u32_u24 v56, 112, v57
  v_add3_u32 v61, v56, v58, s35
  v_mul_u32_u24 v56, 768, v57
  v_add_u32 v7, v56, v58
  s_add_u32 s55, s59, s47
  s_add_u32 s21, s59, 12288
  s_mov_b32 s22, 12288
  s_lshr_b32 s34, s41, 1
  s_and_b32 s35, s41, 1
  s_lshl_b32 s35, s35, 10
  s_add_u32 s23, s65, s35
  s_add_u32 s35, s35, 13312
  s_cmp_eq_u32 s34, 1
  s_cselect_b32 s21, s23, s21
  s_cselect_b32 s22, s35, s22
  s_mov_b32 exec_lo, 0xffffffff
  s_mov_b32 exec_hi, 0x0
  v_lshlrev_b32 v32, 4, v1
  s_mov_b32 s46, 0
  s_mov_b32 s35, 24
lp_16:
  buffer_load_dwordx4 v[34:37], v32, s[16:19], s62 offen sc1
  s_waitcnt vmcnt(0)
  v_xor_b32 v34, s45, v34
  v_xor_b32 v35, s45, v35
  v_xor_b32 v36, s45, v36
  v_xor_b32 v37, s45, v37
  v_or_b32 v34, v34, v35
  v_or3_b32 v34, v34, v36, v37
  v_cmp_ne_u32 vcc, 0, v34
  s_cbranch_vccnz lr_17
ld_18:
  s_mov_b64 exec, -1
  s_add_u32 s54, s55, 0
  s_add_u32 m0, s47, 0
  s_nop 0
  buffer_load_dwordx4 v10, s[16:19], s54 offen sc1 lds
  s_add_u32 s54, s55, 4096
  s_add_u32 m0, s47, 4096
  s_nop 0
  buffer_load_dwordx4 v10, s[16:19], s54 offen sc1 lds
  s_add_u32 s54, s55, 8192
  s_add_u32 m0, s47, 8192
  s_nop 0
  buffer_load_dwordx4 v10, s[16:19], s54 offen sc1 lds
  s_mov_b32 m0, s22
  s_nop 0
  buffer_load_dwordx4 v10, s[16:19], s21 offen sc1 lds
  buffer_load_dwordx4 v[64:67], v10, s[16:19], s60 offen offset:0 sc1
  buffer_load_dwordx4 v[68:71], v10, s[16:19], s60 offen offset:1024 sc1
  buffer_load_dwordx4 v[72:75], v10, s[16:19], s60 offen offset:2048 sc1
  s_add_u32 s60, s60, 24576
  buffer_load_dwordx4 v[76:79], v10, s[16:19], s60 offen offset:0 sc1
  s_waitcnt vmcnt(4)
  s_barrier
  ds_read_b128 v[32:35], v10 offset:0
  ds_read_b128 v[36:39], v10 offset:1024
  ds_read_b128 v[40:43], v10 offset:2048
  ds_read_b32 v24, v54
  ds_read_b128 v[16:19], v55
  s_waitcnt lgkmcnt(4)
  v_mfma_f32_16x16x32_bf16 v[56:59], v[208:211], v[32:35], 0
  ds_read_b128 v[44:47], v10 offset:3072
  buffer_load_dwordx4 v[80:83], v10, s[16:19], s60 offen offset:1024 sc1
  s_waitcnt lgkmcnt(4)
  v_mfma_f32_16x16x32_bf16 v[56:59], v[212:215], v[36:39], v[56:59]
  ds_read_b128 v[32:35], v10 offset:4096
  buffer_load_dwordx4 v[84:87], v10, s[16:19], s60 offen offset:2048 sc1
  s_waitcnt lgkmcnt(4)
  v_mfma_f32_16x16x32_bf16 v[56:59], v[216:219], v[40:43], v[56:59]
  ds_read_b128 v[36:39], v10 offset:5120
  s_add_u32 s60, s60, 24576
  buffer_load_dwordx4 v[88:91], v10, s[16:19], s60 offen offset:0 sc1
  s_waitcnt lgkmcnt(2)
  v_mfma_f32_16x16x32_bf16 v[56:59], v[220:223], v[44:47], v[56:59]
  ds_read_b128 v[40:43], v10 offset:6144
  s_mov_b32 s36, -1
  s_mov_b32 s37, 0
  v_cndmask_b32 v24, 0, v24, s[36:37]
  buffer_load_dwordx4 v[92:95], v10, s[16:19], s60 offen offset:1024 sc1
  s_waitcnt lgkmcnt(2)
  v_mfma_f32_16x16x32_bf16 v[56:59], v[224:227], v[32:35], v[56:59]
  ds_read_b128 v[44:47], v10 offset:7168
  v_mov_b32 v25, v24
  buffer_load_dwordx4 v[96:99], v10, s[16:19], s60 offen offset:2048 sc1
  s_waitcnt lgkmcnt(2)
  v_mfma_f32_16x16x32_bf16 v[56:59], v[228:231], v[36:39], v[56:59]
  ds_read_b128 v[32:35], v10 offset:8192
  v_mov_b32 v26, v24
  s_add_u32 s60, s60, 24576
  buffer_load_dwordx4 v[100:103], v10, s[16:19], s60 offen offset:0 sc1
  s_waitcnt lgkmcnt(2)
  v_mfma_f32_16x16x32_bf16 v[56:59], v[232:235], v[40:43], v[56:59]
  ds_read_b128 v[36:39], v10 offset:9216
  v_mov_b32 v27, v24
  buffer_load_dwordx4 v[104:107], v10, s[16:19], s60 offen offset:1024 sc1
  s_waitcnt lgkmcnt(2)
  v_mfma_f32_16x16x32_bf16 v[56:59], v[236:239], v[44:47], v[56:59]
  ds_read_b128 v[40:43], v10 offset:10240
  buffer_load_dwordx4 v[108:111], v10, s[16:19], s60 offen offset:2048 sc1
  s_waitcnt lgkmcnt(2)
  v_mfma_f32_16x16x32_bf16 v[56:59], v[240:243], v[32:35], v[56:59]
  ds_read_b128 v[44:47], v10 offset:11264
  s_add_u32 s60, s60, 24576
  buffer_load_dwordx4 v[112:115], v10, s[16:19], s60 offen offset:0 sc1
  s_waitcnt lgkmcnt(2)
  v_mfma_f32_16x16x32_bf16 v[56:59], v[244:247], v[36:39], v[56:59]
  ds_read2_b32 v[32:33], v11 offset0:0 offset1:16
  ds_read2_b32 v[34:35], v11 offset0:32 offset1:48
  buffer_load_dwordx4 v[116:119], v10, s[16:19], s60 offen offset:1024 sc1
  s_waitcnt lgkmcnt(3)
  v_mfma_f32_16x16x32_bf16 v[56:59], v[248:251], v[40:43], v[56:59]
  buffer_load_dwordx4 v[120:123], v10, s[16:19], s60 offen offset:2048 sc1
  s_waitcnt lgkmcnt(2)
  v_mfma_f32_16x16x32_bf16 v[56:59], v[252:255], v[44:47], v[56:59]
  s_add_u32 s60, s60, 24576
  buffer_load_dwordx4 v[124:127], v10, s[16:19], s60 offen offset:0 sc1
  s_waitcnt lgkmcnt(0)
  v_mfma_f32_16x16x32_bf16 v[56:59], v[24:27], v[32:35], v[56:59]
  buffer_load_dwordx4 v[128:131], v10, s[16:19], s60 offen offset:1024 sc1
  s_nop 6
  v_mul_f32 v56, v56, v16
  v_mul_f32 v57, v57, v17
  v_mul_f32 v58, v58, v18
  v_mul_f32 v59, v59, v19
  v_max3_f32 v4, v56, v57, v58
  v_max_f32 v4, v4, v59
  v_mov_b32 v5, v4
  buffer_load_dwordx4 v[132:135], v10, s[16:19], s60 offen offset:2048 sc1
  s_nop 0
  v_permlane16_swap_b32 v4, v5
  v_max_f32 v4, v4, v5
  v_mov_b32 v5, v4
  s_add_u32 s60, s60, 24576
  buffer_load_dwordx4 v[136:139], v10, s[16:19], s60 offen offset:0 sc1
  v_permlane32_swap_b32 v4, v5
  v_max_f32 v4, v4, v5
  s_mov_b64 exec, 0xffff
  ds_write_b32 v14, v4
  s_mov_b64 exec, -1
  buffer_load_dwordx4 v[140:143], v10, s[16:19], s60 offen offset:1024 sc1
  s_waitcnt lgkmcnt(0)
  s_barrier
  ds_read_b128 v[32:35], v12
  ds_read_b128 v[36:39], v12 offset:16
  buffer_load_dwordx4 v[144:147], v10, s[16:19], s60 offen offset:2048 sc1
  s_add_u32 s60, s60, 24576
  buffer_load_dwordx4 v[148:151], v10, s[16:19], s60 offen offset:0 sc1
  s_waitcnt lgkmcnt(0)
  v_max3_f32 v4, v32, v33, v34
  v_max3_f32 v5, v35, v36, v37
  v_max3_f32 v4, v4, v38, v39
  v_max_f32 v4, v4, v5
  v_sub_f32 v56, v56, v4
  v_sub_f32 v57, v57, v4
  v_sub_f32 v58, v58, v4
  v_sub_f32 v59, v59, v4
  v_exp_f32 v56, v56
  v_exp_f32 v57, v57
  v_exp_f32 v58, v58
  v_exp_f32 v59, v59
  v_cvt_pk_bf16_f32 v32, v56, v57
  v_cvt_pk_bf16_f32 v33, v58, v59
  ds_write_b64 v13, v[32:33]
  v_add_f32 v56, v56, v58
  v_add_f32 v57, v57, v59
  v_add_f32 v56, v56, v57
  v_mov_b32 v5, v56
  buffer_load_dwordx4 v[152:155], v10, s[16:19], s60 offen offset:1024 sc1
  s_nop 0
  v_permlane16_swap_b32 v56, v5
  v_add_f32 v56, v56, v5
  v_mov_b32 v5, v56
  buffer_load_dwordx4 v[156:159], v10, s[16:19], s60 offen offset:2048 sc1
  s_nop 0
  v_permlane32_swap_b32 v56, v5
  v_add_f32 v56, v56, v5
  s_mov_b64 exec, 0xffff
  ds_write_b32 v14, v56 offset:512
  s_mov_b64 exec, -1
  s_waitcnt lgkmcnt(0)
  s_barrier
  ds_read_b128 v[160:163], v10 offset:16384
  ds_read_b128 v[164:167], v10 offset:17408
  ds_read_b128 v[168:171], v10 offset:18432
  ds_read_b128 v[172:175], v10 offset:19456
  ds_read_b128 v[176:179], v10 offset:20480
  ds_read_b128 v[180:183], v10 offset:21504
  ds_read_b128 v[184:187], v10 offset:22528
  ds_read_b128 v[188:191], v10 offset:23552
  ds_read_b128 v[212:215], v12 offset:512
  ds_read_b128 v[216:219], v12 offset:528
  s_waitcnt vmcnt(21) lgkmcnt(9)
  v_mfma_f32_16x16x32_bf16 v[32:35], v[64:67], v[160:163], 0
  s_mov_b32 s36, 0xffff0000
  v_mfma_f32_16x16x32_bf16 v[36:39], v[68:71], v[160:163], 0
  v_lshlrev_b32 v200, 16, v48
  v_mfma_f32_16x16x32_bf16 v[40:43], v[72:75], v[160:163], 0
  v_and_b32 v201, s36, v48
  s_waitcnt vmcnt(18) lgkmcnt(8)
  v_mfma_f32_16x16x32_bf16 v[32:35], v[76:79], v[164:167], v[32:35]
  v_lshlrev_b32 v202, 16, v49
  v_mfma_f32_16x16x32_bf16 v[36:39], v[80:83], v[164:167], v[36:39]
  v_and_b32 v203, s36, v49
  v_mfma_f32_16x16x32_bf16 v[40:43], v[84:87], v[164:167], v[40:43]
  v_lshlrev_b32 v204, 16, v50
  s_waitcnt vmcnt(15) lgkmcnt(7)
  v_mfma_f32_16x16x32_bf16 v[32:35], v[88:91], v[168:171], v[32:35]
  v_and_b32 v205, s36, v50
  v_mfma_f32_16x16x32_bf16 v[36:39], v[92:95], v[168:171], v[36:39]
  v_lshlrev_b32 v206, 16, v51
  v_mfma_f32_16x16x32_bf16 v[40:43], v[96:99], v[168:171], v[40:43]
  v_and_b32 v207, s36, v51
  s_waitcnt vmcnt(12) lgkmcnt(6)
  v_mfma_f32_16x16x32_bf16 v[32:35], v[100:103], v[172:175], v[32:35]
  v_lshlrev_b32 v208, 16, v52
  v_mfma_f32_16x16x32_bf16 v[36:39], v[104:107], v[172:175], v[36:39]
  v_and_b32 v209, s36, v52
  v_mfma_f32_16x16x32_bf16 v[40:43], v[108:111], v[172:175], v[40:43]
  v_lshlrev_b32 v210, 16, v53
  s_waitcnt vmcnt(9) lgkmcnt(5)
  v_mfma_f32_16x16x32_bf16 v[32:35], v[112:115], v[176:179], v[32:35]
  v_and_b32 v211, s36, v53
  s_waitcnt lgkmcnt(0)
  v_mfma_f32_16x16x32_bf16 v[36:39], v[116:119], v[176:179], v[36:39]
  v_add_f32 v212, v212, v216
  v_add_f32 v213, v213, v217
  v_mfma_f32_16x16x32_bf16 v[40:43], v[120:123], v[176:179], v[40:43]
  v_add_f32 v214, v214, v218
  v_add_f32 v215, v215, v219
  s_waitcnt vmcnt(6)
  v_mfma_f32_16x16x32_bf16 v[32:35], v[124:127], v[180:183], v[32:35]
  v_add_f32 v212, v212, v213
  v_add_f32 v214, v214, v215
  v_mfma_f32_16x16x32_bf16 v[36:39], v[128:131], v[180:183], v[36:39]
  v_add_f32 v212, v212, v214
  v_rcp_f32 v212, v212
  v_mfma_f32_16x16x32_bf16 v[40:43], v[132:135], v[180:183], v[40:43]
  s_waitcnt vmcnt(3)
  v_mfma_f32_16x16x32_bf16 v[32:35], v[136:139], v[184:187], v[32:35]
  v_mfma_f32_16x16x32_bf16 v[36:39], v[140:143], v[184:187], v[36:39]
  v_mfma_f32_16x16x32_bf16 v[40:43], v[144:147], v[184:187], v[40:43]
  s_waitcnt vmcnt(0)
  v_mfma_f32_16x16x32_bf16 v[32:35], v[148:151], v[188:191], v[32:35]
  v_mfma_f32_16x16x32_bf16 v[36:39], v[152:155], v[188:191], v[36:39]
  v_mfma_f32_16x16x32_bf16 v[40:43], v[156:159], v[188:191], v[40:43]
  s_nop 5
  v_pk_fma_f32 v[200:201], v[32:33], v[212:213], v[200:201] op_sel_hi:[1,0,1]
  v_pk_fma_f32 v[202:203], v[34:35], v[212:213], v[202:203] op_sel_hi:[1,0,1]
  v_cvt_pk_bf16_f32 v192, v200, v201
  v_cvt_pk_bf16_f32 v193, v202, v203
  ds_write_b64 v8, v[192:193] offset:0
  v_pk_fma_f32 v[204:205], v[36:37], v[212:213], v[204:205] op_sel_hi:[1,0,1]
  v_pk_fma_f32 v[206:207], v[38:39], v[212:213], v[206:207] op_sel_hi:[1,0,1]
  v_cvt_pk_bf16_f32 v194, v204, v205
  v_cvt_pk_bf16_f32 v195, v206, v207
  ds_write_b64 v8, v[194:195] offset:32
  v_pk_fma_f32 v[208:209], v[40:41], v[212:213], v[208:209] op_sel_hi:[1,0,1]
  v_pk_fma_f32 v[210:211], v[42:43], v[212:213], v[210:211] op_sel_hi:[1,0,1]
  v_cvt_pk_bf16_f32 v196, v208, v209
  v_cvt_pk_bf16_f32 v197, v210, v211
  ds_write_b64 v8, v[196:197] offset:64
  ds_read_b128 v[44:47], v60
  s_mov_b32 exec_hi, 0
  ds_read_b128 v[48:51], v61
  s_mov_b32 exec_hi, -1
  s_waitcnt lgkmcnt(1)
  buffer_store_dwordx4 v[44:47], v6, s[24:27], s61 offen
  s_waitcnt lgkmcnt(0)
  s_mov_b32 exec_hi, 0
  buffer_store_dwordx4 v[48:51], v7, s[24:27], s61 offen
  s_mov_b32 exec_hi, -1
  s_endpgm
P2_l:
  s_cmp_lg_u32 s42, 31
  s_cbranch_scc1 hs_20
  s_cmp_lg_u32 s41, 0
  s_cbranch_scc1 hs_20
  s_lshl_b32 s34, s40, 7
  s_mov_b32 s35, 8020992
  s_mov_b64 exec, 1
  v_mov_b32 v52, s34
  v_mov_b32 v53, s45
  buffer_store_dword v53, v52, s[16:19], s35 offen
  s_mov_b64 exec, -1
hs_20:
  s_and_b32 s68, s42, 7
  s_mul_i32 s68, s68, 79872
  s_mul_i32 s69, s41, 20480
  s_add_u32 s68, s68, s69
  s_add_u32 s68, s68, 4063232
  s_and_b32 s34, s42, 3
  s_mul_i32 s34, s34, 3
  s_lshr_b32 s34, s34, 1
  s_bfe_u32 s35, s42, 0x10002
  s_mul_i32 s35, s35, 18
  s_add_u32 s34, s34, s35
  s_lshl_b32 s34, s34, 7
  s_add_u32 s67, s34, 8036352
  v_lshrrev_b32 v7, 1, v1
  v_mul_u32_u24 v7, 768, v7
  v_and_b32 v33, 1, v1
  v_lshl_add_u32 v7, v33, 7, v7
  s_mov_b32 exec_lo, 0x3f
  s_mov_b32 exec_hi, 0x0
  s_mov_b32 s35, 1048576
gp_21:
  buffer_load_dword v33, v7, s[16:19], s67 offen sc1
  s_waitcnt vmcnt(0)
  v_cmp_ne_u32 vcc, s44, v33
  s_cbranch_vccnz gr_22
gd_23:
  s_mov_b64 exec, -1
  v_lshlrev_b32 v7, 7, v1
  s_add_u32 m0, s69, 0
  s_nop 0
  buffer_load_dwordx4 v10, s[16:19], s68 offen offset:0 sc1 lds
  buffer_load_dwordx4 v10, s[16:19], s68 offen offset:1024 sc1 lds
  buffer_load_dwordx4 v10, s[16:19], s68 offen offset:2048 sc1 lds
  buffer_load_dwordx4 v10, s[16:19], s68 offen offset:3072 sc1 lds
  s_add_u32 m0, s69, 4096
  s_add_u32 s68, s68, 4096
  buffer_load_dwordx4 v10, s[16:19], s68 offen offset:0 sc1 lds
  buffer_load_dwordx4 v10, s[16:19], s68 offen offset:1024 sc1 lds
  buffer_load_dwordx4 v10, s[16:19], s68 offen offset:2048 sc1 lds
  buffer_load_dwordx4 v10, s[16:19], s68 offen offset:3072 sc1 lds
  s_add_u32 m0, s69, 8192
  s_add_u32 s68, s68, 4096
  buffer_load_dwordx4 v10, s[16:19], s68 offen offset:0 sc1 lds
  buffer_load_dwordx4 v10, s[16:19], s68 offen offset:1024 sc1 lds
  buffer_load_dwordx4 v10, s[16:19], s68 offen offset:2048 sc1 lds
  buffer_load_dwordx4 v10, s[16:19], s68 offen offset:3072 sc1 lds
  s_add_u32 m0, s69, 12288
  s_add_u32 s68, s68, 4096
  buffer_load_dwordx4 v10, s[16:19], s68 offen offset:0 sc1 lds
  buffer_load_dwordx4 v10, s[16:19], s68 offen offset:1024 sc1 lds
  buffer_load_dwordx4 v10, s[16:19], s68 offen offset:2048 sc1 lds
  buffer_load_dwordx4 v10, s[16:19], s68 offen offset:3072 sc1 lds
  s_add_u32 m0, s69, 16384
  s_add_u32 s68, s68, 4096
  buffer_load_dwordx4 v10, s[16:19], s68 offen offset:0 sc1 lds
  buffer_load_dwordx4 v10, s[16:19], s68 offen offset:1024 sc1 lds
  buffer_load_dwordx4 v10, s[16:19], s68 offen offset:2048 sc1 lds
  buffer_load_dwordx4 v10, s[16:19], s68 offen offset:3072 sc1 lds
  s_lshr_b32 s50, s42, 3
  s_lshr_b32 s3, s41, 1
  s_lshr_b32 s52, s42, 1
  s_and_b32 s53, s42, 1
  s_mul_i32 s56, s40, 196608
  s_mul_i32 s35, s41, 12288
  s_add_u32 s56, s56, s35
  s_add_u32 s56, s56, 2359296
  v_lshrrev_b32 v2, 4, v1
  v_and_b32 v3, 15, v1
  v_bfe_u32 v5, v1, 4, 1
  s_lshl_b32 s34, s3, 10
  s_and_b32 s35, s41, 1
  s_lshl_b32 s35, s35, 3
  s_add_u32 s34, s34, s35
  s_add_u32 s34, s34, 16384
  v_add_u32 v13, s34, v10
  s_lshl_b32 s34, s41, 2
  s_add_u32 s34, s34, 24592
  v_lshl_add_u32 v14, v3, 5, s34
  v_lshlrev_b32 v12, 5, v3
  v_add_u32 v12, 24576, v12
  v_lshlrev_b32 v11, 2, v3
  v_lshl_add_u32 v11, v5, 8, v11
  v_add_u32 v11, 12288, v11
  s_add_u32 s23, s50, 1
  s_and_b32 s23, s23, 3
  s_mul_i32 s34, s23, 49152
  s_add_u32 s20, s56, s34
  s_lshl_b32 s34, s23, 2
  s_add_u32 s34, s34, s41
  s_lshl_b32 s34, s34, 6
  s_add_u32 s34, s34, 13312
  v_lshl_add_u32 v84, v3, 2, s34
  s_add_u32 s34, s34, 1024
  v_lshl_add_u32 v87, v2, 4, s34
  s_lshl_b32 s34, s23, 11
  v_add_u32 v90, s34, v13
  s_add_u32 s23, s50, 2
  s_and_b32 s23, s23, 3
  s_mul_i32 s34, s23, 49152
  s_add_u32 s21, s56, s34
  s_lshl_b32 s34, s23, 2
  s_add_u32 s34, s34, s41
  s_lshl_b32 s34, s34, 6
  s_add_u32 s34, s34, 13312
  v_lshl_add_u32 v85, v3, 2, s34
  s_add_u32 s34, s34, 1024
  v_lshl_add_u32 v88, v2, 4, s34
  s_lshl_b32 s34, s23, 11
  v_add_u32 v91, s34, v13
  s_add_u32 s23, s50, 3
  s_and_b32 s23, s23, 3
  s_mul_i32 s34, s23, 49152
  s_add_u32 s22, s56, s34
  s_lshl_b32 s34, s23, 2
  s_add_u32 s34, s34, s41
  s_lshl_b32 s34, s34, 6
  s_add_u32 s34, s34, 13312
  v_lshl_add_u32 v86, v3, 2, s34
  s_add_u32 s34, s34, 1024
  v_lshl_add_u32 v89, v2, 4, s34
  s_lshl_b32 s34, s23, 11
  v_add_u32 v92, s34, v13
  s_cmp_ge_u32 s42, 8
  s_cbranch_scc1 hg_25
  s_lshl_b32 s34, s40, 7
  s_add_u32 s34, s34, 8020992
  v_mov_b32 v34, 0
  s_mov_b32 s35, 64
hw_24:
  s_mov_b64 exec, 1
  buffer_load_dword v35, v34, s[16:19], s34 offen sc1
  s_waitcnt vmcnt(0)
  v_cmp_ne_u32 vcc, s45, v35
  s_mov_b64 exec, -1
  s_cbranch_vccz hg_25
  s_sub_u32 s35, s35, 1
  s_cmp_lg_u32 s35, 0
  s_cbranch_scc1 hw_24
hg_25:
  s_mul_i32 s67, s41, 6144
  s_add_u32 s67, s67, 8044544
  s_mov_b32 exec_lo, 0xffffffff
  s_mov_b32 exec_hi, 0xffff
  s_mov_b32 s35, 1048576
gp_26:
  buffer_load_dword v33, v7, s[16:19], s67 offen sc1
  s_waitcnt vmcnt(0)
  v_cmp_ne_u32 vcc, s44, v33
  s_cbranch_vccnz gr_27
gd_28:
  s_mov_b64 exec, -1
  s_barrier
  s_barrier
  buffer_load_dwordx4 v[112:115], v10, s[16:19], s20 offen offset:0 sc1
  buffer_load_dwordx4 v[116:119], v10, s[16:19], s20 offen offset:1024 sc1
  buffer_load_dwordx4 v[120:123], v10, s[16:19], s20 offen offset:2048 sc1
  s_barrier
  buffer_load_dwordx4 v[124:127], v10, s[16:19], s20 offen offset:3072 sc1
  s_add_u32 s20, s20, 4096
  buffer_load_dwordx4 v[128:131], v10, s[16:19], s20 offen offset:0 sc1
  buffer_load_dwordx4 v[132:135], v10, s[16:19], s20 offen offset:1024 sc1
  buffer_load_dwordx4 v[136:139], v10, s[16:19], s20 offen offset:2048 sc1
  buffer_load_dwordx4 v[140:143], v10, s[16:19], s20 offen offset:3072 sc1
  s_barrier
  s_add_u32 s20, s20, 4096
  buffer_load_dwordx4 v[144:147], v10, s[16:19], s20 offen offset:0 sc1
  buffer_load_dwordx4 v[148:151], v10, s[16:19], s20 offen offset:1024 sc1
  buffer_load_dwordx4 v[152:155], v10, s[16:19], s20 offen offset:2048 sc1
  buffer_load_dwordx4 v[156:159], v10, s[16:19], s20 offen offset:3072 sc1
  buffer_load_dwordx4 v[160:163], v10, s[16:19], s21 offen offset:0 sc1
  buffer_load_dwordx4 v[164:167], v10, s[16:19], s21 offen offset:1024 sc1
  s_waitcnt vmcnt(0)
  buffer_load_dwordx4 v[168:171], v10, s[16:19], s21 offen offset:2048 sc1
  buffer_load_dwordx4 v[172:175], v10, s[16:19], s21 offen offset:3072 sc1
  s_add_u32 s21, s21, 4096
  buffer_load_dwordx4 v[176:179], v10, s[16:19], s21 offen offset:0 sc1
  buffer_load_dwordx4 v[180:183], v10, s[16:19], s21 offen offset:1024 sc1
  buffer_load_dwordx4 v[184:187], v10, s[16:19], s21 offen offset:2048 sc1
  buffer_load_dwordx4 v[188:191], v10, s[16:19], s21 offen offset:3072 sc1
  s_add_u32 s21, s21, 4096
  buffer_load_dwordx4 v[192:195], v10, s[16:19], s21 offen offset:0 sc1
  buffer_load_dwordx4 v[196:199], v10, s[16:19], s21 offen offset:1024 sc1
  s_waitcnt vmcnt(0)
  buffer_load_dwordx4 v[200:203], v10, s[16:19], s21 offen offset:2048 sc1
  buffer_load_dwordx4 v[204:207], v10, s[16:19], s21 offen offset:3072 sc1
  buffer_load_dwordx4 v[208:211], v10, s[16:19], s22 offen offset:0 sc1
  buffer_load_dwordx4 v[212:215], v10, s[16:19], s22 offen offset:1024 sc1
  buffer_load_dwordx4 v[216:219], v10, s[16:19], s22 offen offset:2048 sc1
  buffer_load_dwordx4 v[220:223], v10, s[16:19], s22 offen offset:3072 sc1
  s_add_u32 s22, s22, 4096
  buffer_load_dwordx4 v[224:227], v10, s[16:19], s22 offen offset:0 sc1
  buffer_load_dwordx4 v[228:231], v10, s[16:19], s22 offen offset:1024 sc1
  buffer_load_dwordx4 v[232:235], v10, s[16:19], s22 offen offset:2048 sc1
  buffer_load_dwordx4 v[236:239], v10, s[16:19], s22 offen offset:3072 sc1
  s_add_u32 s22, s22, 4096
  buffer_load_dwordx4 v[240:243], v10, s[16:19], s22 offen offset:0 sc1
  buffer_load_dwordx4 v[244:247], v10, s[16:19], s22 offen offset:1024 sc1
  buffer_load_dwordx4 v[248:251], v10, s[16:19], s22 offen offset:2048 sc1
  buffer_load_dwordx4 v[252:255], v10, s[16:19], s22 offen offset:3072 sc1
  s_waitcnt vmcnt(0) lgkmcnt(0)
  s_or_b32 s34, s41, s2
  s_cmp_lg_u32 s34, 0
  s_cbranch_scc1 be_29
  s_mov_b32 s35, 1048576
  v_lshlrev_b32 v7, 7, v1
  s_mov_b32 s20, 8036352
  s_mov_b32 s21, 8044544
  s_mov_b32 s22, 8052736
  s_mov_b32 s23, 8060928
bp_30:
  buffer_load_dword v32, v7, s[16:19], s20 offen sc1
  buffer_load_dword v33, v7, s[16:19], s21 offen sc1
  buffer_load_dword v34, v7, s[16:19], s22 offen sc1
  buffer_load_dword v35, v7, s[16:19], s23 offen sc1
  s_waitcnt vmcnt(0)
  v_xor_b32 v32, s44, v32
  v_xor_b32 v33, s44, v33
  v_xor_b32 v34, s44, v34
  v_xor_b32 v35, s44, v35
  v_or_b32 v32, v32, v33
  v_or3_b32 v32, v32, v34, v35
  s_sub_u32 s35, s35, 1
  v_cmp_ne_u32 vcc, 0, v32
  s_cmp_lg_u32 s35, 0
  s_cselect_b64 vcc, vcc, 0
  s_cbranch_vccnz bp_30
  s_mov_b32 s34, 8077312
  s_mov_b64 exec, 15
  v_lshl_add_u32 v36, v1, 4, 0
  v_mov_b32 v38, s44
  v_mov_b32 v39, s44
  v_mov_b32 v40, s44
  v_mov_b32 v41, s44
  buffer_store_dwordx4 v[38:41], v36, s[16:19], s34 offen sc0 sc1
  s_mov_b64 exec, -1
be_29:
  s_barrier
  ds_read_b128 v[32:35], v10 offset:0
  ds_read_b128 v[36:39], v10 offset:1024
  ds_read_b128 v[40:43], v10 offset:2048
  ds_read_b32 v72, v84
  ds_read_b128 v[60:63], v87
  ds_read_b32 v76, v85
  ds_read_b128 v[64:67], v88
  ds_read_b32 v80, v86
  ds_read_b128 v[68:71], v89
  s_waitcnt lgkmcnt(8)
  v_mfma_f32_16x16x32_bf16 v[48:51], v[112:115], v[32:35], 0
  v_mfma_f32_16x16x32_bf16 v[52:55], v[160:163], v[32:35], 0
  v_mfma_f32_16x16x32_bf16 v[56:59], v[208:211], v[32:35], 0
  ds_read_b128 v[44:47], v10 offset:3072
  s_waitcnt lgkmcnt(8)
  v_mfma_f32_16x16x32_bf16 v[48:51], v[116:119], v[36:39], v[48:51]
  v_mfma_f32_16x16x32_bf16 v[52:55], v[164:167], v[36:39], v[52:55]
  v_mfma_f32_16x16x32_bf16 v[56:59], v[212:215], v[36:39], v[56:59]
  ds_read_b128 v[32:35], v10 offset:4096
  s_waitcnt lgkmcnt(8)
  v_mfma_f32_16x16x32_bf16 v[48:51], v[120:123], v[40:43], v[48:51]
  v_mfma_f32_16x16x32_bf16 v[52:55], v[168:171], v[40:43], v[52:55]
  v_mfma_f32_16x16x32_bf16 v[56:59], v[216:219], v[40:43], v[56:59]
  ds_read_b128 v[36:39], v10 offset:5120
  s_waitcnt lgkmcnt(2)
  v_mfma_f32_16x16x32_bf16 v[48:51], v[124:127], v[44:47], v[48:51]
  v_mfma_f32_16x16x32_bf16 v[52:55], v[172:175], v[44:47], v[52:55]
  v_mfma_f32_16x16x32_bf16 v[56:59], v[220:223], v[44:47], v[56:59]
  ds_read_b128 v[40:43], v10 offset:6144
  s_mov_b32 s36, -1
  s_mov_b32 s37, 0
  v_cndmask_b32 v72, 0, v72, s[36:37]
  v_cndmask_b32 v76, 0, v76, s[36:37]
  v_cndmask_b32 v80, 0, v80, s[36:37]
  s_waitcnt lgkmcnt(2)
  v_mfma_f32_16x16x32_bf16 v[48:51], v[128:131], v[32:35], v[48:51]
  v_mfma_f32_16x16x32_bf16 v[52:55], v[176:179], v[32:35], v[52:55]
  v_mfma_f32_16x16x32_bf16 v[56:59], v[224:227], v[32:35], v[56:59]
  ds_read_b128 v[44:47], v10 offset:7168
  v_mov_b32 v73, v72
  v_mov_b32 v77, v76
  v_mov_b32 v81, v80
  s_waitcnt lgkmcnt(2)
  v_mfma_f32_16x16x32_bf16 v[48:51], v[132:135], v[36:39], v[48:51]
  v_mfma_f32_16x16x32_bf16 v[52:55], v[180:183], v[36:39], v[52:55]
  v_mfma_f32_16x16x32_bf16 v[56:59], v[228:231], v[36:39], v[56:59]
  ds_read_b128 v[32:35], v10 offset:8192
  v_mov_b32 v74, v72
  v_mov_b32 v78, v76
  v_mov_b32 v82, v80
  s_waitcnt lgkmcnt(2)
  v_mfma_f32_16x16x32_bf16 v[48:51], v[136:139], v[40:43], v[48:51]
  v_mfma_f32_16x16x32_bf16 v[52:55], v[184:187], v[40:43], v[52:55]
  v_mfma_f32_16x16x32_bf16 v[56:59], v[232:235], v[40:43], v[56:59]
  ds_read_b128 v[36:39], v10 offset:9216
  v_mov_b32 v75, v72
  v_mov_b32 v79, v76
  v_mov_b32 v83, v80
  s_waitcnt lgkmcnt(2)
  v_mfma_f32_16x16x32_bf16 v[48:51], v[140:143], v[44:47], v[48:51]
  v_mfma_f32_16x16x32_bf16 v[52:55], v[188:191], v[44:47], v[52:55]
  v_mfma_f32_16x16x32_bf16 v[56:59], v[236:239], v[44:47], v[56:59]
  ds_read_b128 v[40:43], v10 offset:10240
  s_waitcnt lgkmcnt(2)
  v_mfma_f32_16x16x32_bf16 v[48:51], v[144:147], v[32:35], v[48:51]
  v_mfma_f32_16x16x32_bf16 v[52:55], v[192:195], v[32:35], v[52:55]
  v_mfma_f32_16x16x32_bf16 v[56:59], v[240:243], v[32:35], v[56:59]
  ds_read_b128 v[44:47], v10 offset:11264
  s_waitcnt lgkmcnt(2)
  v_mfma_f32_16x16x32_bf16 v[48:51], v[148:151], v[36:39], v[48:51]
  v_mfma_f32_16x16x32_bf16 v[52:55], v[196:199], v[36:39], v[52:55]
  v_mfma_f32_16x16x32_bf16 v[56:59], v[244:247], v[36:39], v[56:59]
  ds_read2_b32 v[32:33], v11 offset0:0 offset1:16
  ds_read2_b32 v[34:35], v11 offset0:32 offset1:48
  s_waitcnt lgkmcnt(3)
  v_mfma_f32_16x16x32_bf16 v[48:51], v[152:155], v[40:43], v[48:51]
  v_mfma_f32_16x16x32_bf16 v[52:55], v[200:203], v[40:43], v[52:55]
  v_mfma_f32_16x16x32_bf16 v[56:59], v[248:251], v[40:43], v[56:59]
  s_waitcnt lgkmcnt(2)
  v_mfma_f32_16x16x32_bf16 v[48:51], v[156:159], v[44:47], v[48:51]
  v_mfma_f32_16x16x32_bf16 v[52:55], v[204:207], v[44:47], v[52:55]
  v_mfma_f32_16x16x32_bf16 v[56:59], v[252:255], v[44:47], v[56:59]
  s_waitcnt lgkmcnt(0)
  v_mfma_f32_16x16x32_bf16 v[48:51], v[72:75], v[32:35], v[48:51]
  v_mfma_f32_16x16x32_bf16 v[52:55], v[76:79], v[32:35], v[52:55]
  v_mfma_f32_16x16x32_bf16 v[56:59], v[80:83], v[32:35], v[56:59]
  s_nop 5
  v_mul_f32 v48, v48, v60
  v_mul_f32 v49, v49, v61
  v_mul_f32 v50, v50, v62
  v_mul_f32 v51, v51, v63
  v_mul_f32 v52, v52, v64
  v_mul_f32 v53, v53, v65
  v_mul_f32 v54, v54, v66
  v_mul_f32 v55, v55, v67
  v_mul_f32 v56, v56, v68
  v_mul_f32 v57, v57, v69
  v_mul_f32 v58, v58, v70
  v_mul_f32 v59, v59, v71
  v_max3_f32 v4, v48, v49, v50
  v_max3_f32 v5, v51, v52, v53
  v_max3_f32 v4, v4, v54, v55
  v_max3_f32 v5, v5, v56, v57
  v_max3_f32 v4, v4, v58, v59
  v_max_f32 v4, v4, v5
  v_mov_b32 v5, v4
  s_nop 1
  v_permlane16_swap_b32 v4, v5
  v_max_f32 v4, v4, v5
  v_mov_b32 v5, v4
  s_nop 1
  v_permlane32_swap_b32 v4, v5
  v_max_f32 v4, v4, v5
  s_mov_b64 exec, 0xffff
  ds_write_b32 v14, v4
  s_mov_b64 exec, -1
  s_waitcnt lgkmcnt(0)
  s_barrier
  ds_read_b128 v[32:35], v12
  ds_read_b128 v[36:39], v12 offset:16
  s_waitcnt lgkmcnt(0)
  v_max3_f32 v4, v32, v33, v34
  v_max3_f32 v5, v35, v36, v37
  v_max3_f32 v4, v4, v38, v39
  v_max_f32 v4, v4, v5
  v_sub_f32 v48, v48, v4
  v_sub_f32 v49, v49, v4
  v_sub_f32 v50, v50, v4
  v_sub_f32 v51, v51, v4
  v_sub_f32 v52, v52, v4
  v_sub_f32 v53, v53, v4
  v_sub_f32 v54, v54, v4
  v_sub_f32 v55, v55, v4
  v_sub_f32 v56, v56, v4
  v_sub_f32 v57, v57, v4
  v_sub_f32 v58, v58, v4
  v_sub_f32 v59, v59, v4
  v_exp_f32 v48, v48
  v_exp_f32 v49, v49
  v_exp_f32 v50, v50
  v_exp_f32 v51, v51
  v_cvt_pk_bf16_f32 v32, v48, v49
  v_cvt_pk_bf16_f32 v33, v50, v51
  ds_write_b64 v90, v[32:33]
  v_exp_f32 v52, v52
  v_exp_f32 v53, v53
  v_exp_f32 v54, v54
  v_exp_f32 v55, v55
  v_cvt_pk_bf16_f32 v34, v52, v53
  v_cvt_pk_bf16_f32 v35, v54, v55
  ds_write_b64 v91, v[34:35]
  v_exp_f32 v56, v56
  v_exp_f32 v57, v57
  v_exp_f32 v58, v58
  v_exp_f32 v59, v59
  v_cvt_pk_bf16_f32 v36, v56, v57
  v_cvt_pk_bf16_f32 v37, v58, v59
  ds_write_b64 v92, v[36:37]
  v_add_f32 v48, v48, v52
  v_add_f32 v49, v49, v53
  v_add_f32 v50, v50, v54
  v_add_f32 v51, v51, v55
  v_add_f32 v48, v48, v56
  v_add_f32 v49, v49, v57
  v_add_f32 v50, v50, v58
  v_add_f32 v51, v51, v59
  v_add_f32 v48, v48, v50
  v_add_f32 v49, v49, v51
  v_add_f32 v48, v48, v49
  v_mov_b32 v5, v48
  s_nop 1
  v_permlane16_swap_b32 v48, v5
  v_add_f32 v48, v48, v5
  v_mov_b32 v5, v48
  s_nop 1
  v_permlane32_swap_b32 v48, v5
  v_add_f32 v48, v48, v5
  s_mov_b64 exec, 0xffff
  ds_write_b32 v14, v48 offset:512
  s_mov_b64 exec, -1
  s_waitcnt lgkmcnt(0)
  s_barrier
K_end:
  s_endpgm
lr_3:
  s_sub_u32 s35, s35, 1
  s_cmp_lg_u32 s35, 0
  s_cbranch_scc1 lp_2
  s_mov_b64 exec, -1
  s_add_u32 s34, s56, 8388608
  buffer_store_dwordx4 v[96:99], v18, s[16:19], s34 offen sc0 sc1
  s_waitcnt vmcnt(0)
  s_mov_b64 exec, 1
  v_mov_b32 v34, s62
  v_mov_b32 v35, s44
  buffer_store_dword v35, v34, s[16:19], s61 offen sc0 sc1
  s_mov_b32 exec_lo, 0xfff
  s_mov_b32 exec_hi, 0x0
  s_mov_b32 s35, 1048576
ls_5:
  buffer_load_dword v34, v32, s[16:19], s60 offen sc1
  buffer_load_dword v38, v32, s[16:19], s61 offen sc0 sc1
  s_waitcnt vmcnt(0)
  v_cmp_ne_u32 vcc, s45, v34
  s_cbranch_vccz ld_4
  v_cmp_ne_u32 vcc, s44, v38
  s_mov_b32 s46, 8388608
  s_cbranch_vccz ld_4
  s_mov_b32 s46, 0
  s_sub_u32 s35, s35, 1
  s_cmp_lg_u32 s35, 0
  s_cbranch_scc1 ls_5
  s_branch ld_4
gr_9:
  s_sub_u32 s35, s35, 1
  s_cmp_lg_u32 s35, 0
  s_cbranch_scc1 gp_8
  s_branch gd_10
W_c5:
  s_barrier
  s_barrier
  s_barrier
  s_barrier
  s_barrier
  s_barrier
  s_branch W_c4
W_done3:
  s_branch P2_l
lr_17:
  s_sub_u32 s35, s35, 1
  s_cmp_lg_u32 s35, 0
  s_cbranch_scc1 lp_16
  s_mov_b64 exec, -1
  s_waitcnt vmcnt(0)
  s_mov_b64 exec, 1
  v_mov_b32 v34, s64
  v_mov_b32 v35, s44
  buffer_store_dword v35, v34, s[16:19], s63 offen sc0 sc1
  s_mov_b32 exec_lo, 0xffffffff
  s_mov_b32 exec_hi, 0x0
  s_mov_b32 s35, 1048576
ls_19:
  buffer_load_dwordx4 v[34:37], v32, s[16:19], s62 offen sc1
  buffer_load_dwordx4 v[38:41], v32, s[16:19], s63 offen sc0 sc1
  s_waitcnt vmcnt(0)
  v_xor_b32 v34, s45, v34
  v_xor_b32 v35, s45, v35
  v_xor_b32 v36, s45, v36
  v_xor_b32 v37, s45, v37
  v_or_b32 v34, v34, v35
  v_or3_b32 v34, v34, v36, v37
  v_cmp_ne_u32 vcc, 0, v34
  s_cbranch_vccz ld_18
  v_xor_b32 v38, s44, v38
  v_xor_b32 v39, s44, v39
  v_xor_b32 v40, s44, v40
  v_xor_b32 v41, s44, v41
  v_or_b32 v38, v38, v39
  v_or3_b32 v38, v38, v40, v41
  v_cmp_ne_u32 vcc, 0, v38
  s_mov_b32 s46, 0
  s_cbranch_vccz ld_18
  s_mov_b32 s46, 0
  s_sub_u32 s35, s35, 1
  s_cmp_lg_u32 s35, 0
  s_cbranch_scc1 ls_19
  s_branch ld_18
gr_22:
  s_sub_u32 s35, s35, 1
  s_cmp_lg_u32 s35, 0
  s_cbranch_scc1 gp_21
  s_branch gd_23
gr_27:
  s_sub_u32 s35, s35, 1
  s_cmp_lg_u32 s35, 0
  s_cbranch_scc1 gp_26
  s_branch gd_28
.fill 2048, 4, 0xbf810000
.section .rodata,"a"
.p2align 6
.amdhsa_kernel standalone__video_timesformer__vision_kernel
  .amdhsa_next_free_vgpr 256
  .amdhsa_next_free_sgpr 102
  .amdhsa_accum_offset 256
  .amdhsa_group_segment_fixed_size 0
  .amdhsa_kernarg_size 64
  .amdhsa_user_sgpr_count 2
  .amdhsa_user_sgpr_kernarg_segment_ptr 1
  .amdhsa_system_sgpr_workgroup_id_x 1
.end_amdhsa_kernel
```
